```python
import torch

def _softmax(x, axis=-1):
    return torch.softmax(x, dim=axis)
def _gelu(x):
    return torch.nn.functional.gelu(x, approximate="tanh")
def _silu(x):
    return torch.nn.functional.silu(x)
def _sigmoid(x):
    return torch.sigmoid(x)
def _layernorm(x, axis=-1, eps=1e-5):
    m = x.mean(dim=axis, keepdim=True)
    v = x.var(dim=axis, keepdim=True, unbiased=False)
    return (x - m) / torch.sqrt(v + eps)
def _scatter_add(tgt, idx, src, axis=0):
    return tgt.clone().index_add_(axis, idx, src)
def _segment_sum(src, seg, n):
    out = torch.zeros((n,) + src.shape[1:], dtype=src.dtype)
    return out.index_add_(0, seg, src)
def _pad(x, pw):
    flat = tuple(v for pair in reversed(pw) for v in pair)
    return torch.nn.functional.pad(x, flat)

kernel_name = 'concat_heads__mha_block__spectral_fnet__prompt'

def setup_inputs():

    _w = (lambda a: (lambda t: t.to(torch.bfloat16) if t.is_floating_point() else t)(torch.as_tensor(a)))
    def _A_setup():
        B, S, D, H = 1, 2048, 512, 32
        return {
            "x": _w((lambda *s: torch.randn(*s, dtype=torch.bfloat16) * 0.2)(B, S, D)),
            "wqkv": _w((lambda *s: torch.randn(*s, dtype=torch.bfloat16) * 0.8)(D, 3 * D)),
            "wo": _w((lambda *s: torch.randn(*s, dtype=torch.bfloat16) * 0.2)(D, D)),
        }
    _A_in = _A_setup()

    def _B_setup():
        B, S, D = 1, 2048, 512
        ns = torch.arange(S)[:, None] * torch.arange(S)[None, :]
        nd = torch.arange(D)[:, None] * torch.arange(D)[None, :]
        Ws_re = torch.cos(-2.0 * torch.pi * ns / S).to(float)
        Ws_im = torch.sin(-2.0 * torch.pi * ns / S).to(float)
        Wd_re = torch.cos(-2.0 * torch.pi * nd / D).to(float)
        Wd_im = torch.sin(-2.0 * torch.pi * nd / D).to(float)
        return {
            "x": _w((lambda *s: torch.randn(*s, dtype=torch.bfloat16) * 0.05)(B, S, D)),
            "dft_seq_re": _w(Ws_re),
            "dft_seq_im": _w(Ws_im),
            "dft_hid_re": _w(Wd_re),
            "dft_hid_im": _w(Wd_im),
        }
    _B_in = _B_setup()

    return {
        "A_x": _A_in["x"],
        "A_wqkv": _A_in["wqkv"],
        "A_wo": _A_in["wo"],
        "B_x": _B_in["x"],
        "B_dft_seq_re": _B_in["dft_seq_re"],
        "B_dft_seq_im": _B_in["dft_seq_im"],
        "B_dft_hid_re": _B_in["dft_hid_re"],
        "B_dft_hid_im": _B_in["dft_hid_im"],
    }

def reference(A_x, A_wqkv, A_wo, B_x, B_dft_seq_re, B_dft_seq_im, B_dft_hid_re, B_dft_hid_im):
    def _A_ref(x, wqkv, wo):
        B, S, D = x.shape
        H = 32
        Dh = D // H
        qkv = (lambda x, *d: x.permute(*d))((x @ wqkv).reshape(B, S, 3, H, Dh), 2, 0, 3, 1, 4)
        q, k, v = qkv[0], qkv[1], qkv[2]
        scores = torch.einsum("bhqd,bhkd->bhqk", q, k) * (Dh ** -0.5)
        p = _softmax(scores, axis=-1)
        o = torch.einsum("bhqk,bhkd->bhqd", p, v)
        return (lambda x, *d: x.permute(*d))(o, 0, 2, 1, 3).reshape(B, S, D) @ wo

    def _B_ref(x, dft_seq_re, dft_seq_im, dft_hid_re, dft_hid_im):
        a = torch.einsum("bsd,ed->bse", x, dft_hid_re)
        b = torch.einsum("bsd,ed->bse", x, dft_hid_im)
        y = torch.einsum("ts,bse->bte", dft_seq_re, a) - torch.einsum("ts,bse->bte", dft_seq_im, b)
        return y

    a = _A_ref(A_x, A_wqkv, A_wo)
    b = _B_ref(B_x, B_dft_seq_re, B_dft_seq_im, B_dft_hid_re, B_dft_hid_im)
    return torch.concatenate([a, b], axis=-1)
```

```asm
; @launch grid=(256,1,1) block=(768,1,1) lds=163840
.amdgcn_target "amdgcn-amd-amdhsa--gfx950"
.text
.globl concat_heads__mha_block__spectral_fnet__prompt_kernel
.p2align 8
.type concat_heads__mha_block__spectral_fnet__prompt_kernel,@function
concat_heads__mha_block__spectral_fnet__prompt_kernel:
    s_cmp_ge_u32 s2, 256
    s_cbranch_scc1 K_END
    s_load_dwordx8 s[4:11], s[0:1], 0
    s_load_dwordx4 s[20:23], s[0:1], 64
    s_load_dwordx2 s[24:25], s[0:1], 80
    v_lshrrev_b32 v1, 6, v0
    v_and_b32 v0, 63, v0
    s_and_b32 s44, s2, 7
    v_readfirstlane_b32 s26, v1
    s_lshr_b32 s45, s2, 3
    s_and_b32 s46, s45, 3
    s_lshl_b32 s40, s44, 1
    s_and_b32 s40, s40, 12
    s_add_u32 s40, s40, s46
    s_lshr_b32 s47, s45, 2
    s_lshr_b32 s42, s47, 1
    s_and_b32 s41, s44, 1
    s_lshl_b32 s41, s41, 1
    s_and_b32 s48, s47, 1
    s_add_u32 s41, s41, s48
    s_lshl_b32 s43, s46, 1
    s_add_u32 s43, s43, s47
    s_and_b32 s43, s43, 6
    s_cmp_ge_u32 s26, 8
    s_cbranch_scc1 K_BG
    s_getpc_b64 s[44:45]
PC_HERE:
    s_sub_u32 s44, s44, PC_HERE-concat_heads__mha_block__spectral_fnet__prompt_kernel
    s_subb_u32 s45, s45, 0
    v_lshlrev_b32 v6, 7, v0
    s_lshl_b32 s47, s26, 13
    v_add_u32 v6, s47, v6
    v_min_u32 v6, K_END-concat_heads__mha_block__spectral_fnet__prompt_kernel, v6
    global_load_dword v143, v6, s[44:45]
    s_branch K_MAIN
K_BG:
    s_setprio 2
    s_sub_u32 s33, s26, 8
    s_cmp_eq_u32 s42, 3
    s_cbranch_scc1 BG_F1
    v_lshrrev_b32 v6, 3, v0
    v_and_b32 v8, 7, v0
    v_lshrrev_b32 v9, 4, v0
    v_xor_b32 v8, v8, v9
    v_lshlrev_b32 v8, 4, v8
    v_lshl_add_u32 v16, v6, 10, v8
    v_xor_b32 v17, 64, v16
    v_add_u32 v17, 0x2000, v17
    v_add_u32 v18, 0x4000, v16
    v_add_u32 v19, 0x4000, v17
    s_lshl_b32 s44, s40, 17
    s_lshl_b32 s45, s33, 15
    s_add_u32 s44, s44, s45
    v_mul_u32_u24 v7, 3072, v9
    v_and_b32 v8, 15, v0
    v_lshlrev_b32 v9, 2, v9
    v_xor_b32 v8, v8, v9
    v_lshl_add_u32 v20, v8, 4, v7
    v_add_u32 v21, 12288, v20
    v_add_u32 v22, 24576, v20
    v_add_u32 v23, 36864, v20
    s_lshl_b32 s47, s42, 10
    s_lshl_b32 s48, s41, 8
    s_add_u32 s47, s47, s48
    s_mul_i32 s48, s33, 49152
    s_add_u32 s47, s47, s48
    s_lshl_b32 s51, s33, 12
    s_waitcnt lgkmcnt(0)
    s_mov_b32 s56, s4
    s_mov_b32 s57, s5
    s_mov_b32 s58, 2097152
    s_mov_b32 s59, 0x20000
    s_mov_b32 s36, s6
    s_mov_b32 s37, s7
    s_mov_b32 s38, 1572864
    s_mov_b32 s39, 0x20000
    s_add_u32 s54, s43, 0
    s_and_b32 s54, s54, 7
    s_lshl_b32 s55, s54, 7
    s_add_u32 s55, s55, s44
    s_mul_i32 s54, s54, 196608
    s_add_u32 m0, s51, 0
    s_add_u32 s54, s54, s47
    buffer_load_dwordx4 v16, s[56:59], s55 offen lds
    s_add_u32 m0, s51, 16384
    s_nop 0
    buffer_load_dwordx4 v20, s[36:39], s54 offen lds
    s_add_u32 m0, s51, 1024
    s_nop 0
    buffer_load_dwordx4 v17, s[56:59], s55 offen lds
    s_add_u32 m0, s51, 17408
    s_nop 0
    buffer_load_dwordx4 v21, s[36:39], s54 offen lds
    s_add_u32 m0, s51, 2048
    s_nop 0
    buffer_load_dwordx4 v18, s[56:59], s55 offen lds
    s_add_u32 m0, s51, 18432
    s_nop 0
    buffer_load_dwordx4 v22, s[36:39], s54 offen lds
    s_add_u32 m0, s51, 3072
    s_nop 0
    buffer_load_dwordx4 v19, s[56:59], s55 offen lds
    s_add_u32 m0, s51, 19456
    s_nop 0
    buffer_load_dwordx4 v23, s[36:39], s54 offen lds
    s_add_u32 s54, s43, 1
    s_and_b32 s54, s54, 7
    s_lshl_b32 s55, s54, 7
    s_add_u32 s55, s55, s44
    s_mul_i32 s54, s54, 196608
    s_add_u32 m0, s51, 32768
    s_add_u32 s54, s54, s47
    buffer_load_dwordx4 v16, s[56:59], s55 offen lds
    s_add_u32 m0, s51, 49152
    s_nop 0
    buffer_load_dwordx4 v20, s[36:39], s54 offen lds
    s_add_u32 m0, s51, 33792
    s_nop 0
    buffer_load_dwordx4 v17, s[56:59], s55 offen lds
    s_add_u32 m0, s51, 50176
    s_nop 0
    buffer_load_dwordx4 v21, s[36:39], s54 offen lds
    s_add_u32 m0, s51, 34816
    s_nop 0
    buffer_load_dwordx4 v18, s[56:59], s55 offen lds
    s_add_u32 m0, s51, 51200
    s_nop 0
    buffer_load_dwordx4 v22, s[36:39], s54 offen lds
    s_add_u32 m0, s51, 35840
    s_nop 0
    buffer_load_dwordx4 v19, s[56:59], s55 offen lds
    s_add_u32 m0, s51, 52224
    s_nop 0
    buffer_load_dwordx4 v23, s[36:39], s54 offen lds
    v_lshlrev_b32 v14, 4, v0
    v_mov_b32 v1, 132096
    v_mov_b32 v2, 0
    v_cmp_gt_u32 vcc, 2, v0
    v_lshrrev_b32 v4, 2, v0
    v_lshl_add_u32 v5, v0, 2, v1
    v_cndmask_b32 v3, 0, 3, vcc
    v_cmp_eq_u32 vcc, 2, v4
    s_lshl_b32 s67, s41, 2
    s_add_u32 s67, s67, s42
    v_cndmask_b32 v3, v3, 2, vcc
    s_mov_b64 exec, 0xffff
    ds_write_b32 v5, v3
    s_mov_b64 exec, -1
    s_lshl_b32 s67, s67, 4
    s_add_u32 s67, s67, s40
    s_lshl_b32 s67, s67, 6
    s_add_u32 s67, s67, 7405568
    s_and_b32 s66, s40, 3
    s_cmp_eq_u32 s42, 0
    s_cselect_b32 s66, 0, s66
    s_or_b32 s66, s66, s33
    s_add_u32 s48, s2, s33
    s_cmp_lg_u32 s48, 0
    s_cbranch_scc1 BG_NONONCE
    s_memrealtime s[60:61]
    s_waitcnt lgkmcnt(0)
    s_or_b32 s60, s60, 1
    v_mov_b32 v8, s60
    s_mov_b64 exec, 1
    global_store_dword v2, v8, s[22:23] sc1
    s_mov_b64 exec, -1
BG_NONONCE:
    s_waitcnt vmcnt(8) lgkmcnt(0)
    s_barrier
    s_add_u32 s54, s43, 2
    s_and_b32 s54, s54, 7
    s_lshl_b32 s55, s54, 7
    s_add_u32 s55, s55, s44
    s_mul_i32 s54, s54, 196608
    s_add_u32 m0, s51, 65536
    s_add_u32 s54, s54, s47
    buffer_load_dwordx4 v16, s[56:59], s55 offen lds
    s_add_u32 m0, s51, 81920
    s_nop 0
    buffer_load_dwordx4 v20, s[36:39], s54 offen lds
    s_add_u32 m0, s51, 66560
    s_nop 0
    buffer_load_dwordx4 v17, s[56:59], s55 offen lds
    s_add_u32 m0, s51, 82944
    s_nop 0
    buffer_load_dwordx4 v21, s[36:39], s54 offen lds
    s_add_u32 m0, s51, 67584
    s_nop 0
    buffer_load_dwordx4 v18, s[56:59], s55 offen lds
    s_add_u32 m0, s51, 83968
    s_nop 0
    buffer_load_dwordx4 v22, s[36:39], s54 offen lds
    s_add_u32 m0, s51, 68608
    s_nop 0
    buffer_load_dwordx4 v19, s[56:59], s55 offen lds
    s_add_u32 m0, s51, 84992
    s_nop 0
    buffer_load_dwordx4 v23, s[36:39], s54 offen lds
    s_waitcnt vmcnt(8)
    s_barrier
    s_add_u32 s54, s43, 3
    s_and_b32 s54, s54, 7
    s_lshl_b32 s55, s54, 7
    s_add_u32 s55, s55, s44
    s_mul_i32 s54, s54, 196608
    s_add_u32 m0, s51, 98304
    s_add_u32 s54, s54, s47
    buffer_load_dwordx4 v16, s[56:59], s55 offen lds
    s_add_u32 m0, s51, 114688
    s_nop 0
    buffer_load_dwordx4 v20, s[36:39], s54 offen lds
    s_add_u32 m0, s51, 99328
    s_nop 0
    buffer_load_dwordx4 v17, s[56:59], s55 offen lds
    s_add_u32 m0, s51, 115712
    s_nop 0
    buffer_load_dwordx4 v21, s[36:39], s54 offen lds
    s_add_u32 m0, s51, 100352
    s_nop 0
    buffer_load_dwordx4 v18, s[56:59], s55 offen lds
    s_add_u32 m0, s51, 116736
    s_nop 0
    buffer_load_dwordx4 v22, s[36:39], s54 offen lds
    s_add_u32 m0, s51, 101376
    s_nop 0
    buffer_load_dwordx4 v19, s[56:59], s55 offen lds
    s_add_u32 m0, s51, 117760
    s_nop 0
    buffer_load_dwordx4 v23, s[36:39], s54 offen lds
    s_waitcnt vmcnt(8)
    s_barrier
    s_add_u32 s54, s43, 4
    s_and_b32 s54, s54, 7
    s_lshl_b32 s55, s54, 7
    s_add_u32 s55, s55, s44
    s_mul_i32 s54, s54, 196608
    s_add_u32 m0, s51, 0
    s_add_u32 s54, s54, s47
    buffer_load_dwordx4 v16, s[56:59], s55 offen lds
    s_add_u32 m0, s51, 16384
    s_nop 0
    buffer_load_dwordx4 v20, s[36:39], s54 offen lds
    s_add_u32 m0, s51, 1024
    s_nop 0
    buffer_load_dwordx4 v17, s[56:59], s55 offen lds
    s_add_u32 m0, s51, 17408
    s_nop 0
    buffer_load_dwordx4 v21, s[36:39], s54 offen lds
    s_add_u32 m0, s51, 2048
    s_nop 0
    buffer_load_dwordx4 v18, s[56:59], s55 offen lds
    s_add_u32 m0, s51, 18432
    s_nop 0
    buffer_load_dwordx4 v22, s[36:39], s54 offen lds
    s_add_u32 m0, s51, 3072
    s_nop 0
    buffer_load_dwordx4 v19, s[56:59], s55 offen lds
    s_add_u32 m0, s51, 19456
    s_nop 0
    buffer_load_dwordx4 v23, s[36:39], s54 offen lds
    s_waitcnt vmcnt(8)
    s_barrier
    s_add_u32 s54, s43, 5
    s_and_b32 s54, s54, 7
    s_lshl_b32 s55, s54, 7
    s_add_u32 s55, s55, s44
    s_mul_i32 s54, s54, 196608
    s_add_u32 m0, s51, 32768
    s_add_u32 s54, s54, s47
    buffer_load_dwordx4 v16, s[56:59], s55 offen lds
    s_add_u32 m0, s51, 49152
    s_nop 0
    buffer_load_dwordx4 v20, s[36:39], s54 offen lds
    s_add_u32 m0, s51, 33792
    s_nop 0
    buffer_load_dwordx4 v17, s[56:59], s55 offen lds
    s_add_u32 m0, s51, 50176
    s_nop 0
    buffer_load_dwordx4 v21, s[36:39], s54 offen lds
    s_add_u32 m0, s51, 34816
    s_nop 0
    buffer_load_dwordx4 v18, s[56:59], s55 offen lds
    s_add_u32 m0, s51, 51200
    s_nop 0
    buffer_load_dwordx4 v22, s[36:39], s54 offen lds
    s_add_u32 m0, s51, 35840
    s_nop 0
    buffer_load_dwordx4 v19, s[56:59], s55 offen lds
    s_add_u32 m0, s51, 52224
    s_nop 0
    buffer_load_dwordx4 v23, s[36:39], s54 offen lds
    s_waitcnt vmcnt(8)
    s_barrier
    s_add_u32 s54, s43, 6
    s_and_b32 s54, s54, 7
    s_lshl_b32 s55, s54, 7
    s_add_u32 s55, s55, s44
    s_mul_i32 s54, s54, 196608
    s_add_u32 m0, s51, 65536
    s_add_u32 s54, s54, s47
    buffer_load_dwordx4 v16, s[56:59], s55 offen lds
    s_add_u32 m0, s51, 81920
    s_nop 0
    buffer_load_dwordx4 v20, s[36:39], s54 offen lds
    s_add_u32 m0, s51, 66560
    s_nop 0
    buffer_load_dwordx4 v17, s[56:59], s55 offen lds
    s_add_u32 m0, s51, 82944
    s_nop 0
    buffer_load_dwordx4 v21, s[36:39], s54 offen lds
    s_add_u32 m0, s51, 67584
    s_nop 0
    buffer_load_dwordx4 v18, s[56:59], s55 offen lds
    s_add_u32 m0, s51, 83968
    s_nop 0
    buffer_load_dwordx4 v22, s[36:39], s54 offen lds
    s_add_u32 m0, s51, 68608
    s_nop 0
    buffer_load_dwordx4 v19, s[56:59], s55 offen lds
    s_add_u32 m0, s51, 84992
    s_nop 0
    buffer_load_dwordx4 v23, s[36:39], s54 offen lds
    s_waitcnt vmcnt(8)
    s_barrier
    s_add_u32 s54, s43, 7
    s_and_b32 s54, s54, 7
    s_lshl_b32 s55, s54, 7
    s_add_u32 s55, s55, s44
    s_mul_i32 s54, s54, 196608
    s_add_u32 m0, s51, 98304
    s_add_u32 s54, s54, s47
    buffer_load_dwordx4 v16, s[56:59], s55 offen lds
    s_add_u32 m0, s51, 114688
    s_nop 0
    buffer_load_dwordx4 v20, s[36:39], s54 offen lds
    s_add_u32 m0, s51, 99328
    s_nop 0
    buffer_load_dwordx4 v17, s[56:59], s55 offen lds
    s_add_u32 m0, s51, 115712
    s_nop 0
    buffer_load_dwordx4 v21, s[36:39], s54 offen lds
    s_add_u32 m0, s51, 100352
    s_nop 0
    buffer_load_dwordx4 v18, s[56:59], s55 offen lds
    s_add_u32 m0, s51, 116736
    s_nop 0
    buffer_load_dwordx4 v22, s[36:39], s54 offen lds
    s_add_u32 m0, s51, 101376
    s_nop 0
    buffer_load_dwordx4 v19, s[56:59], s55 offen lds
    s_add_u32 m0, s51, 117760
    s_nop 0
    buffer_load_dwordx4 v23, s[36:39], s54 offen lds
    s_waitcnt vmcnt(8)
    s_barrier
    s_waitcnt vmcnt(0)
    s_barrier
    s_mov_b32 s65, 0
    s_branch BG_J1
BG_F1:
    v_lshlrev_b32 v14, 4, v0
    v_mov_b32 v1, 132096
    v_mov_b32 v2, 0
    v_cmp_gt_u32 vcc, 2, v0
    v_lshrrev_b32 v4, 2, v0
    v_lshl_add_u32 v5, v0, 2, v1
    v_cndmask_b32 v3, 0, 3, vcc
    v_cmp_eq_u32 vcc, 2, v4
    s_lshl_b32 s67, s41, 2
    s_add_u32 s67, s67, s42
    v_cndmask_b32 v3, v3, 2, vcc
    s_mov_b64 exec, 0xffff
    ds_write_b32 v5, v3
    s_mov_b64 exec, -1
    s_lshl_b32 s67, s67, 4
    s_add_u32 s67, s67, s40
    s_lshl_b32 s67, s67, 6
    s_add_u32 s67, s67, 7405568
    s_and_b32 s66, s40, 3
    s_cmp_eq_u32 s42, 0
    s_cselect_b32 s66, 0, s66
    s_or_b32 s66, s66, s33
    s_and_b32 s42, s33, 1
    s_lshr_b32 s64, s33, 1
    s_and_b32 s43, s2, 7
    s_lshl_b32 s43, s43, 3
    s_lshr_b32 s44, s2, 3
    s_add_u32 s43, s43, s44
    s_sub_u32 s43, s43, 24
    s_lshl_b32 s43, s43, 1
    s_add_u32 s43, s43, s64
    v_and_b32 v6, 31, v0
    v_lshrrev_b32 v7, 5, v0
    v_and_b32 v8, 15, v0
    s_lshl_b32 s45, s43, 3
    s_lshl_b32 s46, s42, 2
    s_add_u32 s45, s45, s46
    s_lshl_b32 s46, s33, 13
    s_lshl_b32 s65, s64, 13
    s_add_u32 s65, s65, 32768
    s_lshl_b32 s64, s64, 2
    v_add_u32 v159, s64, v1
    s_waitcnt lgkmcnt(0)
    s_mov_b32 s56, s10
    s_mov_b32 s57, s11
    s_mov_b32 s58, 2097152
    s_mov_b32 s59, 0x20000
    s_add_u32 m0, s46, 0
    s_add_u32 s47, s45, 0
    s_lshl_b32 s44, s47, 10
    buffer_load_dwordx4 v14, s[56:59], s44 offen lds
    s_sub_u32 s44, 2048, s47
    s_cmp_eq_u32 s47, 0
    s_cselect_b32 s44, 1024, s44
    s_add_u32 m0, s46, 1024
    s_lshl_b32 s44, s44, 10
    buffer_load_dwordx4 v14, s[56:59], s44 offen lds
    s_add_u32 m0, s46, 2048
    s_add_u32 s47, s45, 1
    s_lshl_b32 s44, s47, 10
    buffer_load_dwordx4 v14, s[56:59], s44 offen lds
    s_sub_u32 s44, 2048, s47
    s_cmp_eq_u32 s47, 0
    s_cselect_b32 s44, 1024, s44
    s_add_u32 m0, s46, 3072
    s_lshl_b32 s44, s44, 10
    buffer_load_dwordx4 v14, s[56:59], s44 offen lds
    s_add_u32 m0, s46, 4096
    s_add_u32 s47, s45, 2
    s_lshl_b32 s44, s47, 10
    buffer_load_dwordx4 v14, s[56:59], s44 offen lds
    s_sub_u32 s44, 2048, s47
    s_cmp_eq_u32 s47, 0
    s_cselect_b32 s44, 1024, s44
    s_add_u32 m0, s46, 5120
    s_lshl_b32 s44, s44, 10
    buffer_load_dwordx4 v14, s[56:59], s44 offen lds
    s_add_u32 m0, s46, 6144
    s_add_u32 s47, s45, 3
    s_lshl_b32 s44, s47, 10
    buffer_load_dwordx4 v14, s[56:59], s44 offen lds
    s_sub_u32 s44, 2048, s47
    s_cmp_eq_u32 s47, 0
    s_cselect_b32 s44, 1024, s44
    s_add_u32 m0, s46, 7168
    s_lshl_b32 s44, s44, 10
    buffer_load_dwordx4 v14, s[56:59], s44 offen lds
    s_barrier
    s_mov_b32 s28, s24
    s_mov_b32 s29, s25
    s_mov_b32 s30, 14680064
    s_mov_b32 s31, 0x20000
    s_mov_b32 s60, 0xffff0000
    s_mov_b32 s61, 0xffff0000
    s_mov_b32 s62, 0x80008000
    v_mov_b32 v138, s62
    v_cndmask_b32 v138, 0, v138, s[60:61]
    v_bfe_u32 v3, v0, 2, 2
    v_lshl_add_u32 v3, v7, 3, v3
    v_lshlrev_b32 v3, 6, v3
    v_bfe_u32 v4, v0, 4, 1
    v_lshl_add_u32 v3, v4, 5, v3
    v_and_b32 v5, 3, v0
    v_lshl_add_u32 v3, v5, 3, v3
    v_add_u32 v15, s46, v3
    v_lshlrev_b32 v136, 12, v4
    v_lshl_add_u32 v136, v8, 4, v136
    v_lshl_add_u32 v136, v7, 10, v136
    s_lshl_b32 s44, s42, 3
    s_add_u32 s44, s44, s65
    v_add_u32 v136, s44, v136
    v_lshlrev_b32 v158, 2, v8
    v_lshl_add_u32 v158, v7, 8, v158
    s_or_b32 s63, s43, s42
    v_cvt_f32_u32 v9, v8
    v_cvt_f32_u32 v10, v7
    v_cvt_f32_u32 v11, v6
    v_cvt_f32_u32 v12, v4
    v_mul_f32 v13, 1031798784, v9
    v_mul_f32 v3, v9, v10
    v_mul_f32 v3, 0.5, v3
    v_cos_f32 v88, v3
    v_sin_f32 v96, -v3
    v_add_f32 v3, v3, v13
    v_cos_f32 v89, v3
    v_sin_f32 v97, -v3
    v_add_f32 v3, v3, v13
    v_cos_f32 v90, v3
    v_sin_f32 v98, -v3
    v_add_f32 v3, v3, v13
    v_cos_f32 v91, v3
    v_sin_f32 v99, -v3
    v_add_f32 v3, v3, v13
    v_cos_f32 v92, v3
    v_sin_f32 v100, -v3
    v_add_f32 v3, v3, v13
    v_cos_f32 v93, v3
    v_sin_f32 v101, -v3
    v_add_f32 v3, v3, v13
    v_cos_f32 v94, v3
    v_sin_f32 v102, -v3
    v_add_f32 v3, v3, v13
    v_cos_f32 v95, v3
    v_sin_f32 v103, -v3
    v_add_f32 v3, v3, v13
    v_cvt_pk_bf16_f32 v16, v88, v89
    v_cvt_pk_bf16_f32 v20, v96, v97
    v_cvt_pk_bf16_f32 v17, v90, v91
    v_cvt_pk_bf16_f32 v21, v98, v99
    v_cvt_pk_bf16_f32 v18, v92, v93
    v_cvt_pk_bf16_f32 v22, v100, v101
    v_cvt_pk_bf16_f32 v19, v94, v95
    v_cvt_pk_bf16_f32 v23, v102, v103
    v_mul_f32 v13, 989855744, v9
    v_mul_f32 v5, 4.0, v13
    v_mul_f32 v3, v10, v5
    v_mul_f32 v12, 1048576000, v12
    v_add_f32 v3, v3, v12
    v_cos_f32 v48, v3
    v_sin_f32 v64, -v3
    v_add_f32 v3, v3, v13
    v_cos_f32 v49, v3
    v_sin_f32 v65, -v3
    v_add_f32 v3, v3, v13
    v_cos_f32 v50, v3
    v_sin_f32 v66, -v3
    v_add_f32 v3, v3, v13
    v_cos_f32 v51, v3
    v_sin_f32 v67, -v3
    v_add_f32 v3, v3, v13
    v_add_f32 v3, v3, v5
    v_cos_f32 v52, v3
    v_sin_f32 v68, -v3
    v_add_f32 v3, v3, v13
    v_cos_f32 v53, v3
    v_sin_f32 v69, -v3
    v_add_f32 v3, v3, v13
    v_cos_f32 v54, v3
    v_sin_f32 v70, -v3
    v_add_f32 v3, v3, v13
    v_cos_f32 v55, v3
    v_sin_f32 v71, -v3
    v_add_f32 v3, v3, v13
    v_add_f32 v3, v3, v5
    v_cos_f32 v56, v3
    v_sin_f32 v72, -v3
    v_add_f32 v3, v3, v13
    v_cos_f32 v57, v3
    v_sin_f32 v73, -v3
    v_add_f32 v3, v3, v13
    v_cos_f32 v58, v3
    v_sin_f32 v74, -v3
    v_add_f32 v3, v3, v13
    v_cos_f32 v59, v3
    v_sin_f32 v75, -v3
    v_add_f32 v3, v3, v13
    v_add_f32 v3, v3, v5
    v_cos_f32 v60, v3
    v_sin_f32 v76, -v3
    v_add_f32 v3, v3, v13
    v_cos_f32 v61, v3
    v_sin_f32 v77, -v3
    v_add_f32 v3, v3, v13
    v_cos_f32 v62, v3
    v_sin_f32 v78, -v3
    v_add_f32 v3, v3, v13
    v_cos_f32 v63, v3
    v_sin_f32 v79, -v3
    v_add_f32 v3, v3, v13
    v_add_f32 v3, v3, v5
    v_mul_f32 v13, 1023410176, v11
    v_mul_f32 v5, 4.0, v13
    v_mul_f32 v3, v10, v5
    v_cos_f32 v88, v3
    v_sin_f32 v104, v3
    v_add_f32 v3, v3, v13
    v_cos_f32 v89, v3
    v_sin_f32 v105, v3
    v_add_f32 v3, v3, v13
    v_cos_f32 v90, v3
    v_sin_f32 v106, v3
    v_add_f32 v3, v3, v13
    v_cos_f32 v91, v3
    v_sin_f32 v107, v3
    v_add_f32 v3, v3, v13
    v_add_f32 v3, v3, v5
    v_cos_f32 v92, v3
    v_sin_f32 v108, v3
    v_add_f32 v3, v3, v13
    v_cos_f32 v93, v3
    v_sin_f32 v109, v3
    v_add_f32 v3, v3, v13
    v_cos_f32 v94, v3
    v_sin_f32 v110, v3
    v_add_f32 v3, v3, v13
    v_cos_f32 v95, v3
    v_sin_f32 v111, v3
    v_add_f32 v3, v3, v13
    v_add_f32 v3, v3, v5
    v_cos_f32 v96, v3
    v_sin_f32 v112, v3
    v_add_f32 v3, v3, v13
    v_cos_f32 v97, v3
    v_sin_f32 v113, v3
    v_add_f32 v3, v3, v13
    v_cos_f32 v98, v3
    v_sin_f32 v114, v3
    v_add_f32 v3, v3, v13
    v_cos_f32 v99, v3
    v_sin_f32 v115, v3
    v_add_f32 v3, v3, v13
    v_add_f32 v3, v3, v5
    v_cos_f32 v100, v3
    v_sin_f32 v116, v3
    v_add_f32 v3, v3, v13
    v_cos_f32 v101, v3
    v_sin_f32 v117, v3
    v_add_f32 v3, v3, v13
    v_cos_f32 v102, v3
    v_sin_f32 v118, v3
    v_add_f32 v3, v3, v13
    v_cos_f32 v103, v3
    v_sin_f32 v119, v3
    v_add_f32 v3, v3, v13
    v_add_f32 v3, v3, v5
    v_cvt_pk_bf16_f32 v32, v88, v89
    v_cvt_pk_bf16_f32 v40, v104, v105
    v_xor_b32 v24, v138, v16
    v_cvt_pk_bf16_f32 v33, v90, v91
    v_cvt_pk_bf16_f32 v41, v106, v107
    v_xor_b32 v25, v138, v17
    v_cvt_pk_bf16_f32 v34, v92, v93
    v_cvt_pk_bf16_f32 v42, v108, v109
    v_xor_b32 v26, v138, v18
    v_cvt_pk_bf16_f32 v35, v94, v95
    v_cvt_pk_bf16_f32 v43, v110, v111
    v_xor_b32 v27, v138, v19
    v_cvt_pk_bf16_f32 v36, v96, v97
    v_cvt_pk_bf16_f32 v44, v112, v113
    v_xor_b32 v28, v138, v20
    v_cvt_pk_bf16_f32 v37, v98, v99
    v_cvt_pk_bf16_f32 v45, v114, v115
    v_xor_b32 v29, v138, v21
    v_cvt_pk_bf16_f32 v38, v100, v101
    v_cvt_pk_bf16_f32 v46, v116, v117
    v_xor_b32 v30, v138, v22
    v_cvt_pk_bf16_f32 v39, v102, v103
    v_cvt_pk_bf16_f32 v47, v118, v119
    v_xor_b32 v31, v138, v23
    s_waitcnt vmcnt(0)
    ds_read_b64_tr_b16 v[80:81], v15 offset:0
    ds_read_b64_tr_b16 v[82:83], v15 offset:256
    ds_read_b64_tr_b16 v[84:85], v15 offset:1024
    ds_read_b64_tr_b16 v[86:87], v15 offset:1280
    s_cmp_lg_u32 s63, 0
    s_cbranch_scc1 F1_G0
    v_cndmask_b32 v24, 0, v16, s[60:61]
    v_cndmask_b32 v16, v16, 0, s[60:61]
    v_cndmask_b32 v25, 0, v17, s[60:61]
    v_cndmask_b32 v17, v17, 0, s[60:61]
    v_cndmask_b32 v26, 0, v18, s[60:61]
    v_cndmask_b32 v18, v18, 0, s[60:61]
    v_cndmask_b32 v27, 0, v19, s[60:61]
    v_cndmask_b32 v19, v19, 0, s[60:61]
    v_cndmask_b32 v28, 0, v20, s[60:61]
    v_cndmask_b32 v20, v20, 0, s[60:61]
    v_cndmask_b32 v29, 0, v21, s[60:61]
    v_cndmask_b32 v21, v21, 0, s[60:61]
    v_cndmask_b32 v30, 0, v22, s[60:61]
    v_cndmask_b32 v22, v22, 0, s[60:61]
    v_cndmask_b32 v31, 0, v23, s[60:61]
    v_cndmask_b32 v23, v23, 0, s[60:61]
F1_G0:
    s_waitcnt lgkmcnt(0)
    v_mfma_f32_32x32x16_bf16 v[88:103], v[80:83], v[16:19], 0
    v_mfma_f32_32x32x16_bf16 v[104:119], v[80:83], v[20:23], 0
    v_mfma_f32_32x32x16_bf16 v[88:103], v[84:87], v[24:27], v[88:103]
    v_mfma_f32_32x32x16_bf16 v[104:119], v[84:87], v[28:31], v[104:119]
    s_nop 11
    v_mul_f32 v137, v88, v64
    v_mul_f32 v88, v88, v48
    v_fma_f32 v88, -v104, v64, v88
    v_fma_f32 v104, v104, v48, v137
    v_mul_f32 v137, v89, v65
    v_mul_f32 v89, v89, v49
    v_fma_f32 v89, -v105, v65, v89
    v_fma_f32 v105, v105, v49, v137
    v_mul_f32 v137, v90, v66
    v_mul_f32 v90, v90, v50
    v_fma_f32 v90, -v106, v66, v90
    v_fma_f32 v106, v106, v50, v137
    v_mul_f32 v137, v91, v67
    v_mul_f32 v91, v91, v51
    v_fma_f32 v91, -v107, v67, v91
    v_fma_f32 v107, v107, v51, v137
    v_mul_f32 v137, v92, v68
    v_mul_f32 v92, v92, v52
    v_fma_f32 v92, -v108, v68, v92
    v_fma_f32 v108, v108, v52, v137
    v_mul_f32 v137, v93, v69
    v_mul_f32 v93, v93, v53
    v_fma_f32 v93, -v109, v69, v93
    v_fma_f32 v109, v109, v53, v137
    v_mul_f32 v137, v94, v70
    v_mul_f32 v94, v94, v54
    v_fma_f32 v94, -v110, v70, v94
    v_fma_f32 v110, v110, v54, v137
    v_mul_f32 v137, v95, v71
    v_mul_f32 v95, v95, v55
    v_fma_f32 v95, -v111, v71, v95
    v_fma_f32 v111, v111, v55, v137
    v_mul_f32 v137, v96, v72
    v_mul_f32 v96, v96, v56
    v_fma_f32 v96, -v112, v72, v96
    v_fma_f32 v112, v112, v56, v137
    v_mul_f32 v137, v97, v73
    v_mul_f32 v97, v97, v57
    v_fma_f32 v97, -v113, v73, v97
    v_fma_f32 v113, v113, v57, v137
    v_mul_f32 v137, v98, v74
    v_mul_f32 v98, v98, v58
    v_fma_f32 v98, -v114, v74, v98
    v_fma_f32 v114, v114, v58, v137
    v_mul_f32 v137, v99, v75
    v_mul_f32 v99, v99, v59
    v_fma_f32 v99, -v115, v75, v99
    v_fma_f32 v115, v115, v59, v137
    v_mul_f32 v137, v100, v76
    v_mul_f32 v100, v100, v60
    v_fma_f32 v100, -v116, v76, v100
    v_fma_f32 v116, v116, v60, v137
    v_mul_f32 v137, v101, v77
    v_mul_f32 v101, v101, v61
    v_fma_f32 v101, -v117, v77, v101
    v_fma_f32 v117, v117, v61, v137
    v_mul_f32 v137, v102, v78
    v_mul_f32 v102, v102, v62
    v_fma_f32 v102, -v118, v78, v102
    v_fma_f32 v118, v118, v62, v137
    v_mul_f32 v137, v103, v79
    v_mul_f32 v103, v103, v63
    v_fma_f32 v103, -v119, v79, v103
    v_fma_f32 v119, v119, v63, v137
    v_cvt_pk_bf16_f32 v120, v88, v89
    v_cvt_pk_bf16_f32 v128, v104, v105
    v_cvt_pk_bf16_f32 v121, v90, v91
    v_cvt_pk_bf16_f32 v129, v106, v107
    v_cvt_pk_bf16_f32 v122, v92, v93
    v_cvt_pk_bf16_f32 v130, v108, v109
    v_cvt_pk_bf16_f32 v123, v94, v95
    v_cvt_pk_bf16_f32 v131, v110, v111
    v_cvt_pk_bf16_f32 v124, v96, v97
    v_cvt_pk_bf16_f32 v132, v112, v113
    v_cvt_pk_bf16_f32 v125, v98, v99
    v_cvt_pk_bf16_f32 v133, v114, v115
    v_cvt_pk_bf16_f32 v126, v100, v101
    v_cvt_pk_bf16_f32 v134, v116, v117
    v_cvt_pk_bf16_f32 v127, v102, v103
    v_cvt_pk_bf16_f32 v135, v118, v119
    s_cmp_lg_u32 s63, 0
    s_cbranch_scc1 F1_G1
    v_xor_b32 v137, s62, v128
    v_cndmask_b32 v128, v128, v120, s[60:61]
    v_cndmask_b32 v120, v120, v137, s[60:61]
    v_or_b32 v16, v16, v24
    v_xor_b32 v24, v138, v16
    v_xor_b32 v137, s62, v129
    v_cndmask_b32 v129, v129, v121, s[60:61]
    v_cndmask_b32 v121, v121, v137, s[60:61]
    v_or_b32 v17, v17, v25
    v_xor_b32 v25, v138, v17
    v_xor_b32 v137, s62, v130
    v_cndmask_b32 v130, v130, v122, s[60:61]
    v_cndmask_b32 v122, v122, v137, s[60:61]
    v_or_b32 v18, v18, v26
    v_xor_b32 v26, v138, v18
    v_xor_b32 v137, s62, v131
    v_cndmask_b32 v131, v131, v123, s[60:61]
    v_cndmask_b32 v123, v123, v137, s[60:61]
    v_or_b32 v19, v19, v27
    v_xor_b32 v27, v138, v19
    v_xor_b32 v137, s62, v132
    v_cndmask_b32 v132, v132, v124, s[60:61]
    v_cndmask_b32 v124, v124, v137, s[60:61]
    v_or_b32 v20, v20, v28
    v_xor_b32 v28, v138, v20
    v_xor_b32 v137, s62, v133
    v_cndmask_b32 v133, v133, v125, s[60:61]
    v_cndmask_b32 v125, v125, v137, s[60:61]
    v_or_b32 v21, v21, v29
    v_xor_b32 v29, v138, v21
    v_xor_b32 v137, s62, v134
    v_cndmask_b32 v134, v134, v126, s[60:61]
    v_cndmask_b32 v126, v126, v137, s[60:61]
    v_or_b32 v22, v22, v30
    v_xor_b32 v30, v138, v22
    v_xor_b32 v137, s62, v135
    v_cndmask_b32 v135, v135, v127, s[60:61]
    v_cndmask_b32 v127, v127, v137, s[60:61]
    v_or_b32 v23, v23, v31
    v_xor_b32 v31, v138, v23
F1_G1:
    s_nop 1
    v_mfma_f32_32x32x16_bf16 v[88:103], v[32:35], v[120:123], 0
    v_mfma_f32_32x32x16_bf16 v[88:103], v[36:39], v[124:127], v[88:103]
    v_mfma_f32_32x32x16_bf16 v[88:103], v[40:43], v[128:131], v[88:103]
    v_mfma_f32_32x32x16_bf16 v[88:103], v[44:47], v[132:135], v[88:103]
    s_nop 11
    s_cmp_lg_u32 s63, 0
    s_cbranch_scc1 F1_G2
    s_mov_b32 s44, 7340032
    s_mov_b64 exec, s[60:61]
    buffer_store_dword v88, v158, s[28:31], s44 offen offset:0 sc1
    buffer_store_dword v89, v158, s[28:31], s44 offen offset:64 sc1
    buffer_store_dword v90, v158, s[28:31], s44 offen offset:128 sc1
    buffer_store_dword v91, v158, s[28:31], s44 offen offset:192 sc1
    buffer_store_dword v92, v158, s[28:31], s44 offen offset:512 sc1
    buffer_store_dword v93, v158, s[28:31], s44 offen offset:576 sc1
    buffer_store_dword v94, v158, s[28:31], s44 offen offset:640 sc1
    buffer_store_dword v95, v158, s[28:31], s44 offen offset:704 sc1
    s_mov_b64 exec, 0x10000
    buffer_store_dword v96, v158, s[28:31], s44 offen offset:1024 sc1
    s_mov_b64 exec, -1
F1_G2:
    v_mov_b32 v3, v88
    v_mov_b32 v4, v89
    v_mov_b32 v5, v90
    v_mov_b32 v8, v91
    v_mov_b32 v9, v92
    v_mov_b32 v10, v93
    v_mov_b32 v11, v94
    v_mov_b32 v12, v95
    v_mov_b32 v13, v96
    ds_read_b64_tr_b16 v[80:81], v15 offset:2048
    ds_read_b64_tr_b16 v[82:83], v15 offset:2304
    ds_read_b64_tr_b16 v[84:85], v15 offset:3072
    ds_read_b64_tr_b16 v[86:87], v15 offset:3328
    s_waitcnt lgkmcnt(0)
    v_mfma_f32_32x32x16_bf16 v[88:103], v[80:83], v[16:19], 0
    v_mfma_f32_32x32x16_bf16 v[104:119], v[80:83], v[20:23], 0
    v_mfma_f32_32x32x16_bf16 v[88:103], v[84:87], v[24:27], v[88:103]
    v_mfma_f32_32x32x16_bf16 v[104:119], v[84:87], v[28:31], v[104:119]
    s_nop 11
    v_mul_f32 v137, v88, v64
    v_mul_f32 v88, v88, v48
    v_fma_f32 v88, -v104, v64, v88
    v_fma_f32 v104, v104, v48, v137
    v_mul_f32 v137, v89, v65
    v_mul_f32 v89, v89, v49
    v_fma_f32 v89, -v105, v65, v89
    v_fma_f32 v105, v105, v49, v137
    v_mul_f32 v137, v90, v66
    v_mul_f32 v90, v90, v50
    v_fma_f32 v90, -v106, v66, v90
    v_fma_f32 v106, v106, v50, v137
    v_mul_f32 v137, v91, v67
    v_mul_f32 v91, v91, v51
    v_fma_f32 v91, -v107, v67, v91
    v_fma_f32 v107, v107, v51, v137
    v_mul_f32 v137, v92, v68
    v_mul_f32 v92, v92, v52
    v_fma_f32 v92, -v108, v68, v92
    v_fma_f32 v108, v108, v52, v137
    v_mul_f32 v137, v93, v69
    v_mul_f32 v93, v93, v53
    v_fma_f32 v93, -v109, v69, v93
    v_fma_f32 v109, v109, v53, v137
    v_mul_f32 v137, v94, v70
    v_mul_f32 v94, v94, v54
    v_fma_f32 v94, -v110, v70, v94
    v_fma_f32 v110, v110, v54, v137
    v_mul_f32 v137, v95, v71
    v_mul_f32 v95, v95, v55
    v_fma_f32 v95, -v111, v71, v95
    v_fma_f32 v111, v111, v55, v137
    v_mul_f32 v137, v96, v72
    v_mul_f32 v96, v96, v56
    v_fma_f32 v96, -v112, v72, v96
    v_fma_f32 v112, v112, v56, v137
    v_mul_f32 v137, v97, v73
    v_mul_f32 v97, v97, v57
    v_fma_f32 v97, -v113, v73, v97
    v_fma_f32 v113, v113, v57, v137
    v_mul_f32 v137, v98, v74
    v_mul_f32 v98, v98, v58
    v_fma_f32 v98, -v114, v74, v98
    v_fma_f32 v114, v114, v58, v137
    v_mul_f32 v137, v99, v75
    v_mul_f32 v99, v99, v59
    v_fma_f32 v99, -v115, v75, v99
    v_fma_f32 v115, v115, v59, v137
    v_mul_f32 v137, v100, v76
    v_mul_f32 v100, v100, v60
    v_fma_f32 v100, -v116, v76, v100
    v_fma_f32 v116, v116, v60, v137
    v_mul_f32 v137, v101, v77
    v_mul_f32 v101, v101, v61
    v_fma_f32 v101, -v117, v77, v101
    v_fma_f32 v117, v117, v61, v137
    v_mul_f32 v137, v102, v78
    v_mul_f32 v102, v102, v62
    v_fma_f32 v102, -v118, v78, v102
    v_fma_f32 v118, v118, v62, v137
    v_mul_f32 v137, v103, v79
    v_mul_f32 v103, v103, v63
    v_fma_f32 v103, -v119, v79, v103
    v_fma_f32 v119, v119, v63, v137
    v_cvt_pk_bf16_f32 v120, v88, v89
    v_cvt_pk_bf16_f32 v128, v104, v105
    v_cvt_pk_bf16_f32 v121, v90, v91
    v_cvt_pk_bf16_f32 v129, v106, v107
    v_cvt_pk_bf16_f32 v122, v92, v93
    v_cvt_pk_bf16_f32 v130, v108, v109
    v_cvt_pk_bf16_f32 v123, v94, v95
    v_cvt_pk_bf16_f32 v131, v110, v111
    v_cvt_pk_bf16_f32 v124, v96, v97
    v_cvt_pk_bf16_f32 v132, v112, v113
    v_cvt_pk_bf16_f32 v125, v98, v99
    v_cvt_pk_bf16_f32 v133, v114, v115
    v_cvt_pk_bf16_f32 v126, v100, v101
    v_cvt_pk_bf16_f32 v134, v116, v117
    v_cvt_pk_bf16_f32 v127, v102, v103
    v_cvt_pk_bf16_f32 v135, v118, v119
    s_nop 1
    v_mfma_f32_32x32x16_bf16 v[88:103], v[32:35], v[120:123], 0
    v_mfma_f32_32x32x16_bf16 v[88:103], v[36:39], v[124:127], v[88:103]
    v_mfma_f32_32x32x16_bf16 v[88:103], v[40:43], v[128:131], v[88:103]
    v_mfma_f32_32x32x16_bf16 v[88:103], v[44:47], v[132:135], v[88:103]
    s_nop 11
    v_cvt_pk_bf16_f32 v140, v3, v88
    v_cvt_pk_bf16_f32 v142, v4, v89
    v_cvt_pk_bf16_f32 v144, v5, v90
    v_cvt_pk_bf16_f32 v146, v8, v91
    v_cvt_pk_bf16_f32 v148, v9, v92
    v_cvt_pk_bf16_f32 v150, v10, v93
    v_cvt_pk_bf16_f32 v152, v11, v94
    v_cvt_pk_bf16_f32 v154, v12, v95
    v_cvt_pk_bf16_f32 v156, v13, v96
    ds_read_b64_tr_b16 v[80:81], v15 offset:4096
    ds_read_b64_tr_b16 v[82:83], v15 offset:4352
    ds_read_b64_tr_b16 v[84:85], v15 offset:5120
    ds_read_b64_tr_b16 v[86:87], v15 offset:5376
    s_waitcnt lgkmcnt(0)
    v_mfma_f32_32x32x16_bf16 v[88:103], v[80:83], v[16:19], 0
    v_mfma_f32_32x32x16_bf16 v[104:119], v[80:83], v[20:23], 0
    v_mfma_f32_32x32x16_bf16 v[88:103], v[84:87], v[24:27], v[88:103]
    v_mfma_f32_32x32x16_bf16 v[104:119], v[84:87], v[28:31], v[104:119]
    s_nop 11
    v_mul_f32 v137, v88, v64
    v_mul_f32 v88, v88, v48
    v_fma_f32 v88, -v104, v64, v88
    v_fma_f32 v104, v104, v48, v137
    v_mul_f32 v137, v89, v65
    v_mul_f32 v89, v89, v49
    v_fma_f32 v89, -v105, v65, v89
    v_fma_f32 v105, v105, v49, v137
    v_mul_f32 v137, v90, v66
    v_mul_f32 v90, v90, v50
    v_fma_f32 v90, -v106, v66, v90
    v_fma_f32 v106, v106, v50, v137
    v_mul_f32 v137, v91, v67
    v_mul_f32 v91, v91, v51
    v_fma_f32 v91, -v107, v67, v91
    v_fma_f32 v107, v107, v51, v137
    v_mul_f32 v137, v92, v68
    v_mul_f32 v92, v92, v52
    v_fma_f32 v92, -v108, v68, v92
    v_fma_f32 v108, v108, v52, v137
    v_mul_f32 v137, v93, v69
    v_mul_f32 v93, v93, v53
    v_fma_f32 v93, -v109, v69, v93
    v_fma_f32 v109, v109, v53, v137
    v_mul_f32 v137, v94, v70
    v_mul_f32 v94, v94, v54
    v_fma_f32 v94, -v110, v70, v94
    v_fma_f32 v110, v110, v54, v137
    v_mul_f32 v137, v95, v71
    v_mul_f32 v95, v95, v55
    v_fma_f32 v95, -v111, v71, v95
    v_fma_f32 v111, v111, v55, v137
    v_mul_f32 v137, v96, v72
    v_mul_f32 v96, v96, v56
    v_fma_f32 v96, -v112, v72, v96
    v_fma_f32 v112, v112, v56, v137
    v_mul_f32 v137, v97, v73
    v_mul_f32 v97, v97, v57
    v_fma_f32 v97, -v113, v73, v97
    v_fma_f32 v113, v113, v57, v137
    v_mul_f32 v137, v98, v74
    v_mul_f32 v98, v98, v58
    v_fma_f32 v98, -v114, v74, v98
    v_fma_f32 v114, v114, v58, v137
    v_mul_f32 v137, v99, v75
    v_mul_f32 v99, v99, v59
    v_fma_f32 v99, -v115, v75, v99
    v_fma_f32 v115, v115, v59, v137
    v_mul_f32 v137, v100, v76
    v_mul_f32 v100, v100, v60
    v_fma_f32 v100, -v116, v76, v100
    v_fma_f32 v116, v116, v60, v137
    v_mul_f32 v137, v101, v77
    v_mul_f32 v101, v101, v61
    v_fma_f32 v101, -v117, v77, v101
    v_fma_f32 v117, v117, v61, v137
    v_mul_f32 v137, v102, v78
    v_mul_f32 v102, v102, v62
    v_fma_f32 v102, -v118, v78, v102
    v_fma_f32 v118, v118, v62, v137
    v_mul_f32 v137, v103, v79
    v_mul_f32 v103, v103, v63
    v_fma_f32 v103, -v119, v79, v103
    v_fma_f32 v119, v119, v63, v137
    v_cvt_pk_bf16_f32 v120, v88, v89
    v_cvt_pk_bf16_f32 v128, v104, v105
    v_cvt_pk_bf16_f32 v121, v90, v91
    v_cvt_pk_bf16_f32 v129, v106, v107
    v_cvt_pk_bf16_f32 v122, v92, v93
    v_cvt_pk_bf16_f32 v130, v108, v109
    v_cvt_pk_bf16_f32 v123, v94, v95
    v_cvt_pk_bf16_f32 v131, v110, v111
    v_cvt_pk_bf16_f32 v124, v96, v97
    v_cvt_pk_bf16_f32 v132, v112, v113
    v_cvt_pk_bf16_f32 v125, v98, v99
    v_cvt_pk_bf16_f32 v133, v114, v115
    v_cvt_pk_bf16_f32 v126, v100, v101
    v_cvt_pk_bf16_f32 v134, v116, v117
    v_cvt_pk_bf16_f32 v127, v102, v103
    v_cvt_pk_bf16_f32 v135, v118, v119
    s_nop 1
    v_mfma_f32_32x32x16_bf16 v[88:103], v[32:35], v[120:123], 0
    v_mfma_f32_32x32x16_bf16 v[88:103], v[36:39], v[124:127], v[88:103]
    v_mfma_f32_32x32x16_bf16 v[88:103], v[40:43], v[128:131], v[88:103]
    v_mfma_f32_32x32x16_bf16 v[88:103], v[44:47], v[132:135], v[88:103]
    s_nop 11
    v_mov_b32 v3, v88
    v_mov_b32 v4, v89
    v_mov_b32 v5, v90
    v_mov_b32 v8, v91
    v_mov_b32 v9, v92
    v_mov_b32 v10, v93
    v_mov_b32 v11, v94
    v_mov_b32 v12, v95
    v_mov_b32 v13, v96
    ds_read_b64_tr_b16 v[80:81], v15 offset:6144
    ds_read_b64_tr_b16 v[82:83], v15 offset:6400
    ds_read_b64_tr_b16 v[84:85], v15 offset:7168
    ds_read_b64_tr_b16 v[86:87], v15 offset:7424
    s_waitcnt lgkmcnt(0)
    v_mfma_f32_32x32x16_bf16 v[88:103], v[80:83], v[16:19], 0
    v_mfma_f32_32x32x16_bf16 v[104:119], v[80:83], v[20:23], 0
    v_mfma_f32_32x32x16_bf16 v[88:103], v[84:87], v[24:27], v[88:103]
    v_mfma_f32_32x32x16_bf16 v[104:119], v[84:87], v[28:31], v[104:119]
    s_nop 11
    v_mul_f32 v137, v88, v64
    v_mul_f32 v88, v88, v48
    v_fma_f32 v88, -v104, v64, v88
    v_fma_f32 v104, v104, v48, v137
    v_mul_f32 v137, v89, v65
    v_mul_f32 v89, v89, v49
    v_fma_f32 v89, -v105, v65, v89
    v_fma_f32 v105, v105, v49, v137
    v_mul_f32 v137, v90, v66
    v_mul_f32 v90, v90, v50
    v_fma_f32 v90, -v106, v66, v90
    v_fma_f32 v106, v106, v50, v137
    v_mul_f32 v137, v91, v67
    v_mul_f32 v91, v91, v51
    v_fma_f32 v91, -v107, v67, v91
    v_fma_f32 v107, v107, v51, v137
    v_mul_f32 v137, v92, v68
    v_mul_f32 v92, v92, v52
    v_fma_f32 v92, -v108, v68, v92
    v_fma_f32 v108, v108, v52, v137
    v_mul_f32 v137, v93, v69
    v_mul_f32 v93, v93, v53
    v_fma_f32 v93, -v109, v69, v93
    v_fma_f32 v109, v109, v53, v137
    v_mul_f32 v137, v94, v70
    v_mul_f32 v94, v94, v54
    v_fma_f32 v94, -v110, v70, v94
    v_fma_f32 v110, v110, v54, v137
    v_mul_f32 v137, v95, v71
    v_mul_f32 v95, v95, v55
    v_fma_f32 v95, -v111, v71, v95
    v_fma_f32 v111, v111, v55, v137
    v_mul_f32 v137, v96, v72
    v_mul_f32 v96, v96, v56
    v_fma_f32 v96, -v112, v72, v96
    v_fma_f32 v112, v112, v56, v137
    v_mul_f32 v137, v97, v73
    v_mul_f32 v97, v97, v57
    v_fma_f32 v97, -v113, v73, v97
    v_fma_f32 v113, v113, v57, v137
    v_mul_f32 v137, v98, v74
    v_mul_f32 v98, v98, v58
    v_fma_f32 v98, -v114, v74, v98
    v_fma_f32 v114, v114, v58, v137
    v_mul_f32 v137, v99, v75
    v_mul_f32 v99, v99, v59
    v_fma_f32 v99, -v115, v75, v99
    v_fma_f32 v115, v115, v59, v137
    v_mul_f32 v137, v100, v76
    v_mul_f32 v100, v100, v60
    v_fma_f32 v100, -v116, v76, v100
    v_fma_f32 v116, v116, v60, v137
    v_mul_f32 v137, v101, v77
    v_mul_f32 v101, v101, v61
    v_fma_f32 v101, -v117, v77, v101
    v_fma_f32 v117, v117, v61, v137
    v_mul_f32 v137, v102, v78
    v_mul_f32 v102, v102, v62
    v_fma_f32 v102, -v118, v78, v102
    v_fma_f32 v118, v118, v62, v137
    v_mul_f32 v137, v103, v79
    v_mul_f32 v103, v103, v63
    v_fma_f32 v103, -v119, v79, v103
    v_fma_f32 v119, v119, v63, v137
    v_cvt_pk_bf16_f32 v120, v88, v89
    v_cvt_pk_bf16_f32 v128, v104, v105
    v_cvt_pk_bf16_f32 v121, v90, v91
    v_cvt_pk_bf16_f32 v129, v106, v107
    v_cvt_pk_bf16_f32 v122, v92, v93
    v_cvt_pk_bf16_f32 v130, v108, v109
    v_cvt_pk_bf16_f32 v123, v94, v95
    v_cvt_pk_bf16_f32 v131, v110, v111
    v_cvt_pk_bf16_f32 v124, v96, v97
    v_cvt_pk_bf16_f32 v132, v112, v113
    v_cvt_pk_bf16_f32 v125, v98, v99
    v_cvt_pk_bf16_f32 v133, v114, v115
    v_cvt_pk_bf16_f32 v126, v100, v101
    v_cvt_pk_bf16_f32 v134, v116, v117
    v_cvt_pk_bf16_f32 v127, v102, v103
    v_cvt_pk_bf16_f32 v135, v118, v119
    s_nop 1
    v_mfma_f32_32x32x16_bf16 v[88:103], v[32:35], v[120:123], 0
    v_mfma_f32_32x32x16_bf16 v[88:103], v[36:39], v[124:127], v[88:103]
    v_mfma_f32_32x32x16_bf16 v[88:103], v[40:43], v[128:131], v[88:103]
    v_mfma_f32_32x32x16_bf16 v[88:103], v[44:47], v[132:135], v[88:103]
    s_nop 11
    v_cvt_pk_bf16_f32 v141, v3, v88
    v_cvt_pk_bf16_f32 v143, v4, v89
    v_cvt_pk_bf16_f32 v145, v5, v90
    v_cvt_pk_bf16_f32 v147, v8, v91
    v_cvt_pk_bf16_f32 v149, v9, v92
    v_cvt_pk_bf16_f32 v151, v10, v93
    v_cvt_pk_bf16_f32 v153, v11, v94
    v_cvt_pk_bf16_f32 v155, v12, v95
    v_cvt_pk_bf16_f32 v157, v13, v96
    ds_write_b64 v136, v[140:141] offset:0
    ds_write_b64 v136, v[142:143] offset:256
    ds_write_b64 v136, v[144:145] offset:512
    ds_write_b64 v136, v[146:147] offset:768
    ds_write_b64 v136, v[148:149] offset:2048
    ds_write_b64 v136, v[150:151] offset:2304
    ds_write_b64 v136, v[152:153] offset:2560
    ds_write_b64 v136, v[154:155] offset:2816
    s_mov_b64 exec, 1
    ds_write_b64 v136, v[156:157] offset:4096
    s_mov_b64 exec, -1
    v_mov_b32 v137, 1
    s_mov_b64 exec, 1
    s_waitcnt lgkmcnt(0)
    ds_add_u32 v159, v137 offset:48
    s_mov_b64 exec, -1
F1_SB:
    ds_read_b32 v137, v159 offset:48
    s_waitcnt lgkmcnt(0)
    v_readfirstlane_b32 s44, v137
    s_cmp_ge_u32 s44, 2
    s_cbranch_scc0 F1_SB
    s_lshl_b32 s44, s42, 12
    s_add_u32 s44, s44, s65
    v_add_u32 v3, s44, v14
    ds_read_b128 v[16:19], v3 offset:0
    ds_read_b128 v[20:23], v3 offset:1024
    ds_read_b128 v[24:27], v3 offset:2048
    ds_read_b128 v[28:31], v3 offset:3072
    v_lshlrev_b32 v4, 4, v6
    v_lshl_add_u32 v4, v7, 16, v4
    s_lshl_b32 s44, s43, 9
    s_lshl_b32 s45, s42, 19
    s_add_u32 s44, s44, s45
    s_add_u32 s44, s44, 6291456
    s_waitcnt lgkmcnt(3)
    buffer_store_dwordx4 v[16:19], v4, s[28:31], s44 offen sc1
    s_add_u32 s44, s44, 0x20000
    s_waitcnt lgkmcnt(2)
    buffer_store_dwordx4 v[20:23], v4, s[28:31], s44 offen sc1
    s_add_u32 s44, s44, 0x20000
    s_waitcnt lgkmcnt(1)
    buffer_store_dwordx4 v[24:27], v4, s[28:31], s44 offen sc1
    s_add_u32 s44, s44, 0x20000
    s_waitcnt lgkmcnt(0)
    buffer_store_dwordx4 v[28:31], v4, s[28:31], s44 offen sc1
    s_add_u32 s44, s44, 0x20000
    s_mov_b32 s68, 65536
F1_NSP:
    global_load_dword v8, v2, s[22:23] sc1
    s_sub_u32 s68, s68, 1
    s_waitcnt vmcnt(0)
    v_readfirstlane_b32 s27, v8
    s_cbranch_scc1 F1_NOK
    s_cmp_eq_u32 s27, 0
    s_cbranch_scc1 F1_NSP
F1_NOK:
    s_lshl_b32 s44, s43, 6
    s_lshl_b32 s45, s42, 5
    s_add_u32 s44, s44, s45
    s_add_u32 s44, s44, 7471104
    s_mov_b64 exec, 1
    buffer_store_dword v8, v2, s[28:31], s44 offen sc1
    s_mov_b64 exec, -1
    s_lshr_b32 s44, s43, 1
    s_lshr_b32 s45, s44, 1
    s_lshl_b32 s45, s45, 5
    v_add_u32 v6, s45, v6
    s_and_b32 s45, s44, 1
    s_mul_i32 s46, s45, 1048576000
    v_mov_b32 v8, s46
    v_cmp_gt_u32 vcc, s45, v6
    v_mov_b32 v9, 1024
    s_lshl_b32 s46, s33, 5
    v_cndmask_b32 v6, v6, v9, vcc
    v_cndmask_b32 v8, v8, 0, vcc
    v_cvt_f32_u32 v6, v6
    v_mul_f32 v6, 973078528, v6
    v_add_u32 v7, s46, v7
    v_lshlrev_b32 v7, 3, v7
    v_cvt_f32_u32 v7, v7
    v_fma_f32 v8, v6, v7, v8
    v_mul_f32 v7, 1098907648, v6
    s_lshl_b32 s64, s44, 16
    s_lshl_b32 s46, s33, 14
    s_add_u32 s64, s64, s46
    s_add_u32 s64, s64, 10485760
    s_lshl_b32 s65, s44, 6
    s_lshl_b32 s46, s33, 4
    s_add_u32 s65, s65, s46
    s_add_u32 s65, s65, 7503872
    s_mov_b32 s66, 1
    v_fract_f32 v9, v8
    v_add_f32 v8, v8, v7
    v_cos_f32 v16, v9
    v_add_f32 v9, v9, v6
    v_cos_f32 v17, v9
    v_add_f32 v9, v9, v6
    v_cos_f32 v18, v9
    v_add_f32 v9, v9, v6
    v_cos_f32 v19, v9
    v_add_f32 v9, v9, v6
    v_cos_f32 v20, v9
    v_add_f32 v9, v9, v6
    v_cos_f32 v21, v9
    v_add_f32 v9, v9, v6
    v_cos_f32 v22, v9
    v_add_f32 v9, v9, v6
    v_cos_f32 v23, v9
    s_nop 0
    v_cvt_pk_bf16_f32 v64, v16, v17
    v_cvt_pk_bf16_f32 v65, v18, v19
    v_cvt_pk_bf16_f32 v66, v20, v21
    v_cvt_pk_bf16_f32 v67, v22, v23
    v_fract_f32 v9, v8
    v_add_f32 v8, v8, v7
    v_cos_f32 v16, v9
    v_add_f32 v9, v9, v6
    v_cos_f32 v17, v9
    v_add_f32 v9, v9, v6
    v_cos_f32 v18, v9
    v_add_f32 v9, v9, v6
    v_cos_f32 v19, v9
    v_add_f32 v9, v9, v6
    v_cos_f32 v20, v9
    v_add_f32 v9, v9, v6
    v_cos_f32 v21, v9
    v_add_f32 v9, v9, v6
    v_cos_f32 v22, v9
    v_add_f32 v9, v9, v6
    v_cos_f32 v23, v9
    s_nop 0
    v_cvt_pk_bf16_f32 v68, v16, v17
    v_cvt_pk_bf16_f32 v69, v18, v19
    v_cvt_pk_bf16_f32 v70, v20, v21
    v_cvt_pk_bf16_f32 v71, v22, v23
    v_fract_f32 v9, v8
    v_add_f32 v8, v8, v7
    v_cos_f32 v16, v9
    v_add_f32 v9, v9, v6
    v_cos_f32 v17, v9
    v_add_f32 v9, v9, v6
    v_cos_f32 v18, v9
    v_add_f32 v9, v9, v6
    v_cos_f32 v19, v9
    v_add_f32 v9, v9, v6
    v_cos_f32 v20, v9
    v_add_f32 v9, v9, v6
    v_cos_f32 v21, v9
    v_add_f32 v9, v9, v6
    v_cos_f32 v22, v9
    v_add_f32 v9, v9, v6
    v_cos_f32 v23, v9
    s_nop 0
    v_cvt_pk_bf16_f32 v72, v16, v17
    v_cvt_pk_bf16_f32 v73, v18, v19
    v_cvt_pk_bf16_f32 v74, v20, v21
    v_cvt_pk_bf16_f32 v75, v22, v23
    v_fract_f32 v9, v8
    v_add_f32 v8, v8, v7
    v_cos_f32 v16, v9
    v_add_f32 v9, v9, v6
    v_cos_f32 v17, v9
    v_add_f32 v9, v9, v6
    v_cos_f32 v18, v9
    v_add_f32 v9, v9, v6
    v_cos_f32 v19, v9
    v_add_f32 v9, v9, v6
    v_cos_f32 v20, v9
    v_add_f32 v9, v9, v6
    v_cos_f32 v21, v9
    v_add_f32 v9, v9, v6
    v_cos_f32 v22, v9
    v_add_f32 v9, v9, v6
    v_cos_f32 v23, v9
    s_nop 0
    v_cvt_pk_bf16_f32 v76, v16, v17
    v_cvt_pk_bf16_f32 v77, v18, v19
    v_cvt_pk_bf16_f32 v78, v20, v21
    v_cvt_pk_bf16_f32 v79, v22, v23
    v_fract_f32 v9, v8
    v_add_f32 v8, v8, v7
    v_cos_f32 v16, v9
    v_add_f32 v9, v9, v6
    v_cos_f32 v17, v9
    v_add_f32 v9, v9, v6
    v_cos_f32 v18, v9
    v_add_f32 v9, v9, v6
    v_cos_f32 v19, v9
    v_add_f32 v9, v9, v6
    v_cos_f32 v20, v9
    v_add_f32 v9, v9, v6
    v_cos_f32 v21, v9
    v_add_f32 v9, v9, v6
    v_cos_f32 v22, v9
    v_add_f32 v9, v9, v6
    v_cos_f32 v23, v9
    s_nop 0
    v_cvt_pk_bf16_f32 v80, v16, v17
    v_cvt_pk_bf16_f32 v81, v18, v19
    v_cvt_pk_bf16_f32 v82, v20, v21
    v_cvt_pk_bf16_f32 v83, v22, v23
    v_fract_f32 v9, v8
    v_add_f32 v8, v8, v7
    v_cos_f32 v16, v9
    v_add_f32 v9, v9, v6
    v_cos_f32 v17, v9
    v_add_f32 v9, v9, v6
    v_cos_f32 v18, v9
    v_add_f32 v9, v9, v6
    v_cos_f32 v19, v9
    v_add_f32 v9, v9, v6
    v_cos_f32 v20, v9
    v_add_f32 v9, v9, v6
    v_cos_f32 v21, v9
    v_add_f32 v9, v9, v6
    v_cos_f32 v22, v9
    v_add_f32 v9, v9, v6
    v_cos_f32 v23, v9
    s_nop 0
    v_cvt_pk_bf16_f32 v84, v16, v17
    v_cvt_pk_bf16_f32 v85, v18, v19
    v_cvt_pk_bf16_f32 v86, v20, v21
    v_cvt_pk_bf16_f32 v87, v22, v23
    v_fract_f32 v9, v8
    v_add_f32 v8, v8, v7
    v_cos_f32 v16, v9
    v_add_f32 v9, v9, v6
    v_cos_f32 v17, v9
    v_add_f32 v9, v9, v6
    v_cos_f32 v18, v9
    v_add_f32 v9, v9, v6
    v_cos_f32 v19, v9
    v_add_f32 v9, v9, v6
    v_cos_f32 v20, v9
    v_add_f32 v9, v9, v6
    v_cos_f32 v21, v9
    v_add_f32 v9, v9, v6
    v_cos_f32 v22, v9
    v_add_f32 v9, v9, v6
    v_cos_f32 v23, v9
    s_nop 0
    v_cvt_pk_bf16_f32 v88, v16, v17
    v_cvt_pk_bf16_f32 v89, v18, v19
    v_cvt_pk_bf16_f32 v90, v20, v21
    v_cvt_pk_bf16_f32 v91, v22, v23
    v_fract_f32 v9, v8
    v_add_f32 v8, v8, v7
    v_cos_f32 v16, v9
    v_add_f32 v9, v9, v6
    v_cos_f32 v17, v9
    v_add_f32 v9, v9, v6
    v_cos_f32 v18, v9
    v_add_f32 v9, v9, v6
    v_cos_f32 v19, v9
    v_add_f32 v9, v9, v6
    v_cos_f32 v20, v9
    v_add_f32 v9, v9, v6
    v_cos_f32 v21, v9
    v_add_f32 v9, v9, v6
    v_cos_f32 v22, v9
    v_add_f32 v9, v9, v6
    v_cos_f32 v23, v9
    s_nop 0
    v_cvt_pk_bf16_f32 v92, v16, v17
    v_cvt_pk_bf16_f32 v93, v18, v19
    v_cvt_pk_bf16_f32 v94, v20, v21
    v_cvt_pk_bf16_f32 v95, v22, v23
    v_fract_f32 v9, v8
    v_add_f32 v8, v8, v7
    v_cos_f32 v16, v9
    v_add_f32 v9, v9, v6
    v_cos_f32 v17, v9
    v_add_f32 v9, v9, v6
    v_cos_f32 v18, v9
    v_add_f32 v9, v9, v6
    v_cos_f32 v19, v9
    v_add_f32 v9, v9, v6
    v_cos_f32 v20, v9
    v_add_f32 v9, v9, v6
    v_cos_f32 v21, v9
    v_add_f32 v9, v9, v6
    v_cos_f32 v22, v9
    v_add_f32 v9, v9, v6
    v_cos_f32 v23, v9
    s_nop 0
    v_cvt_pk_bf16_f32 v96, v16, v17
    v_cvt_pk_bf16_f32 v97, v18, v19
    v_cvt_pk_bf16_f32 v98, v20, v21
    v_cvt_pk_bf16_f32 v99, v22, v23
    v_fract_f32 v9, v8
    v_add_f32 v8, v8, v7
    v_cos_f32 v16, v9
    v_add_f32 v9, v9, v6
    v_cos_f32 v17, v9
    v_add_f32 v9, v9, v6
    v_cos_f32 v18, v9
    v_add_f32 v9, v9, v6
    v_cos_f32 v19, v9
    v_add_f32 v9, v9, v6
    v_cos_f32 v20, v9
    v_add_f32 v9, v9, v6
    v_cos_f32 v21, v9
    v_add_f32 v9, v9, v6
    v_cos_f32 v22, v9
    v_add_f32 v9, v9, v6
    v_cos_f32 v23, v9
    s_nop 0
    v_cvt_pk_bf16_f32 v100, v16, v17
    v_cvt_pk_bf16_f32 v101, v18, v19
    v_cvt_pk_bf16_f32 v102, v20, v21
    v_cvt_pk_bf16_f32 v103, v22, v23
    v_fract_f32 v9, v8
    v_add_f32 v8, v8, v7
    v_cos_f32 v16, v9
    v_add_f32 v9, v9, v6
    v_cos_f32 v17, v9
    v_add_f32 v9, v9, v6
    v_cos_f32 v18, v9
    v_add_f32 v9, v9, v6
    v_cos_f32 v19, v9
    v_add_f32 v9, v9, v6
    v_cos_f32 v20, v9
    v_add_f32 v9, v9, v6
    v_cos_f32 v21, v9
    v_add_f32 v9, v9, v6
    v_cos_f32 v22, v9
    v_add_f32 v9, v9, v6
    v_cos_f32 v23, v9
    s_nop 0
    v_cvt_pk_bf16_f32 v104, v16, v17
    v_cvt_pk_bf16_f32 v105, v18, v19
    v_cvt_pk_bf16_f32 v106, v20, v21
    v_cvt_pk_bf16_f32 v107, v22, v23
    v_fract_f32 v9, v8
    v_add_f32 v8, v8, v7
    v_cos_f32 v16, v9
    v_add_f32 v9, v9, v6
    v_cos_f32 v17, v9
    v_add_f32 v9, v9, v6
    v_cos_f32 v18, v9
    v_add_f32 v9, v9, v6
    v_cos_f32 v19, v9
    v_add_f32 v9, v9, v6
    v_cos_f32 v20, v9
    v_add_f32 v9, v9, v6
    v_cos_f32 v21, v9
    v_add_f32 v9, v9, v6
    v_cos_f32 v22, v9
    v_add_f32 v9, v9, v6
    v_cos_f32 v23, v9
    s_nop 0
    v_cvt_pk_bf16_f32 v108, v16, v17
    v_cvt_pk_bf16_f32 v109, v18, v19
    v_cvt_pk_bf16_f32 v110, v20, v21
    v_cvt_pk_bf16_f32 v111, v22, v23
    v_fract_f32 v9, v8
    v_add_f32 v8, v8, v7
    v_cos_f32 v16, v9
    v_add_f32 v9, v9, v6
    v_cos_f32 v17, v9
    v_add_f32 v9, v9, v6
    v_cos_f32 v18, v9
    v_add_f32 v9, v9, v6
    v_cos_f32 v19, v9
    v_add_f32 v9, v9, v6
    v_cos_f32 v20, v9
    v_add_f32 v9, v9, v6
    v_cos_f32 v21, v9
    v_add_f32 v9, v9, v6
    v_cos_f32 v22, v9
    v_add_f32 v9, v9, v6
    v_cos_f32 v23, v9
    s_nop 0
    v_cvt_pk_bf16_f32 v112, v16, v17
    v_cvt_pk_bf16_f32 v113, v18, v19
    v_cvt_pk_bf16_f32 v114, v20, v21
    v_cvt_pk_bf16_f32 v115, v22, v23
    v_fract_f32 v9, v8
    v_add_f32 v8, v8, v7
    v_cos_f32 v16, v9
    v_add_f32 v9, v9, v6
    v_cos_f32 v17, v9
    v_add_f32 v9, v9, v6
    v_cos_f32 v18, v9
    v_add_f32 v9, v9, v6
    v_cos_f32 v19, v9
    v_add_f32 v9, v9, v6
    v_cos_f32 v20, v9
    v_add_f32 v9, v9, v6
    v_cos_f32 v21, v9
    v_add_f32 v9, v9, v6
    v_cos_f32 v22, v9
    v_add_f32 v9, v9, v6
    v_cos_f32 v23, v9
    s_nop 0
    v_cvt_pk_bf16_f32 v116, v16, v17
    v_cvt_pk_bf16_f32 v117, v18, v19
    v_cvt_pk_bf16_f32 v118, v20, v21
    v_cvt_pk_bf16_f32 v119, v22, v23
    v_fract_f32 v9, v8
    v_add_f32 v8, v8, v7
    v_cos_f32 v16, v9
    v_add_f32 v9, v9, v6
    v_cos_f32 v17, v9
    v_add_f32 v9, v9, v6
    v_cos_f32 v18, v9
    v_add_f32 v9, v9, v6
    v_cos_f32 v19, v9
    v_add_f32 v9, v9, v6
    v_cos_f32 v20, v9
    v_add_f32 v9, v9, v6
    v_cos_f32 v21, v9
    v_add_f32 v9, v9, v6
    v_cos_f32 v22, v9
    v_add_f32 v9, v9, v6
    v_cos_f32 v23, v9
    s_nop 0
    v_cvt_pk_bf16_f32 v120, v16, v17
    v_cvt_pk_bf16_f32 v121, v18, v19
    v_cvt_pk_bf16_f32 v122, v20, v21
    v_cvt_pk_bf16_f32 v123, v22, v23
    v_fract_f32 v9, v8
    v_add_f32 v8, v8, v7
    v_cos_f32 v16, v9
    v_add_f32 v9, v9, v6
    v_cos_f32 v17, v9
    v_add_f32 v9, v9, v6
    v_cos_f32 v18, v9
    v_add_f32 v9, v9, v6
    v_cos_f32 v19, v9
    v_add_f32 v9, v9, v6
    v_cos_f32 v20, v9
    v_add_f32 v9, v9, v6
    v_cos_f32 v21, v9
    v_add_f32 v9, v9, v6
    v_cos_f32 v22, v9
    v_add_f32 v9, v9, v6
    v_cos_f32 v23, v9
    s_nop 0
    v_cvt_pk_bf16_f32 v124, v16, v17
    v_cvt_pk_bf16_f32 v125, v18, v19
    v_cvt_pk_bf16_f32 v126, v20, v21
    v_cvt_pk_bf16_f32 v127, v22, v23
BG_J1:
    s_mov_b32 s28, s24
    s_mov_b32 s29, s25
    s_mov_b32 s30, 14680064
    s_mov_b32 s31, 0x20000
    s_mov_b32 s68, 65536
BG_NSP:
    global_load_dword v8, v2, s[22:23] sc1
    s_sub_u32 s68, s68, 1
    s_waitcnt vmcnt(0)
    v_readfirstlane_b32 s27, v8
    s_cbranch_scc1 BG_NOK
    s_cmp_eq_u32 s27, 0
    s_cbranch_scc1 BG_NSP
BG_NOK:
    ds_write_b32 v1, v8 offset:16
    s_and_b32 s40, s2, 7
    s_lshr_b32 s41, s2, 3
    s_lshl_b32 s40, s40, 2
    s_lshr_b32 s45, s41, 3
    s_add_u32 s40, s40, s45
    s_and_b32 s41, s41, 7
    s_and_b32 s34, s33, 1
    s_lshr_b32 s50, s33, 1
    v_and_b32 v9, 15, v0
    v_lshlrev_b32 v9, 6, v9
    s_lshl_b32 s45, s34, 10
    s_add_u32 s45, s45, 1024
    v_add_u32 v9, s45, v9
    s_lshl_b32 s45, s41, 1
    s_add_u32 s45, s45, s50
    s_lshl_b32 s45, s45, 6
    v_mov_b32 v10, s45
    v_cmp_eq_u32 vcc, 16, v0
    s_lshr_b32 s45, s40, 3
    s_lshl_b32 s45, s45, 12
    s_add_u32 s45, s45, 7405568
    v_cndmask_b32 v9, v9, v10, vcc
    s_lshl_b32 s34, s34, 10
    s_lshl_b32 s35, s40, 17
    s_add_u32 s35, s35, s34
    s_add_u32 s35, s35, 2097152
    v_mul_u32_u24 v11, 2064, v0
    v_mov_b32 v40, 0x3f803f80
    v_mov_b32 v41, v40
    v_mov_b32 v42, v40
    v_mov_b32 v43, v40
    s_lshr_b32 s48, s34, 8
    v_add_u32 v20, s48, v1
    s_lshl_b32 s36, s40, 6
    s_lshl_b32 s37, s41, 3
    s_add_u32 s36, s36, s37
    s_lshl_b32 s37, s33, 1
    s_add_u32 s36, s36, s37
    s_lshl_b32 s36, s36, 10
    s_lshl_b32 s37, s33, 11
    s_add_u32 s37, s37, 132352
    s_lshl_b32 s48, s50, 2
    s_lshl_b32 s53, 1, s48
    s_or_b32 s53, s53, 0x10000
    s_waitcnt lgkmcnt(0)
    s_barrier
    s_cmp_lg_u32 s66, 0
    s_cbranch_scc1 BG_NOFLAG
    s_mov_b64 exec, 1
    buffer_store_dword v8, v2, s[28:31], s67 offen sc1
    s_mov_b64 exec, -1
BG_NOFLAG:
    ds_write_b128 v11, v[40:43] offset:2048
    s_mov_b32 s68, 65536
BG1_SP:
    buffer_load_dword v10, v9, s[28:31], s45 offen sc1
    s_sub_u32 s68, s68, 1
    s_waitcnt vmcnt(0)
    v_cmp_eq_u32 vcc, s27, v10
    s_cbranch_scc1 BG1_OK
    s_and_b32 s46, vcc_lo, s53
    s_cmp_eq_u32 s46, s53
    s_cbranch_scc0 BG1_SP
BG1_OK:
    s_mov_b32 s46, vcc_lo
    s_mul_i32 s52, s50, 8256
    s_add_u32 m0, s52, s34
    s_lshl_b32 s51, s48, 13
    s_add_u32 s51, s51, s35
    buffer_load_dwordx4 v14, s[28:31], s51 offen sc1 lds
    s_add_u32 m0, m0, 2064
    s_add_u32 s51, s51, 2048
    buffer_load_dwordx4 v14, s[28:31], s51 offen sc1 lds
    s_add_u32 m0, m0, 2064
    s_add_u32 s51, s51, 2048
    buffer_load_dwordx4 v14, s[28:31], s51 offen sc1 lds
    s_add_u32 m0, m0, 2064
    s_add_u32 s51, s51, 2048
    buffer_load_dwordx4 v14, s[28:31], s51 offen sc1 lds
    s_mov_b32 m0, s37
    s_mov_b32 s49, 0
    buffer_load_dwordx4 v14, s[28:31], s36 offen sc1 lds
    buffer_load_dwordx4 v14, s[28:31], s36 offen offset:1024 sc1 lds
    s_waitcnt vmcnt(0) lgkmcnt(0)
    s_barrier
BGL_LOOP:
    s_add_u32 s50, s50, 2
    s_and_b32 s48, s50, 3
    s_lshl_b32 s48, s48, 2
    s_lshr_b32 s47, s50, 2
    s_add_u32 s48, s48, s47
    s_bitcmp1_b32 s46, s48
    s_cbranch_scc1 BGL_RDY
    s_waitcnt vmcnt(0)
    v_mov_b32 v21, s49
    s_mov_b64 exec, 1
    ds_or_b32 v20, v21
    s_mov_b64 exec, -1
    s_mov_b32 s68, 65536
BGL_SP:
    buffer_load_dword v10, v9, s[28:31], s45 offen sc1
    s_sub_u32 s68, s68, 1
    s_waitcnt vmcnt(0)
    v_cmp_eq_u32 vcc, s27, v10
    s_cbranch_scc1 BGL_RDY
    s_mov_b32 s46, vcc_lo
    s_bitcmp1_b32 s46, s48
    s_cbranch_scc0 BGL_SP
BGL_RDY:
    s_mul_i32 s52, s50, 8256
    s_add_u32 m0, s52, s34
    s_lshl_b32 s51, s48, 13
    s_add_u32 s51, s51, s35
    buffer_load_dwordx4 v14, s[28:31], s51 offen sc1 lds
    s_add_u32 m0, m0, 2064
    s_add_u32 s51, s51, 2048
    buffer_load_dwordx4 v14, s[28:31], s51 offen sc1 lds
    s_add_u32 m0, m0, 2064
    s_add_u32 s51, s51, 2048
    buffer_load_dwordx4 v14, s[28:31], s51 offen sc1 lds
    s_add_u32 m0, m0, 2064
    s_add_u32 s51, s51, 2048
    buffer_load_dwordx4 v14, s[28:31], s51 offen sc1 lds
    s_waitcnt vmcnt(4)
    v_mov_b32 v21, s49
    s_mov_b64 exec, 1
    ds_or_b32 v20, v21
    s_mov_b64 exec, -1
    s_cmp_eq_u32 s65, 0
    s_cbranch_scc1 BGL_NOTAB
    s_lshr_b32 s47, s50, 1
    s_cmp_lg_u32 s47, 6
    s_cbranch_scc1 BGL_NOTAB
    buffer_store_dwordx4 v[64:67], v14, s[28:31], s64 offen offset:0 sc1
    buffer_store_dwordx4 v[68:71], v14, s[28:31], s64 offen offset:1024 sc1
    buffer_store_dwordx4 v[72:75], v14, s[28:31], s64 offen offset:2048 sc1
    buffer_store_dwordx4 v[76:79], v14, s[28:31], s64 offen offset:3072 sc1
    s_add_u32 s64, s64, 4096
    buffer_store_dwordx4 v[80:83], v14, s[28:31], s64 offen offset:0 sc1
    buffer_store_dwordx4 v[84:87], v14, s[28:31], s64 offen offset:1024 sc1
    buffer_store_dwordx4 v[88:91], v14, s[28:31], s64 offen offset:2048 sc1
    buffer_store_dwordx4 v[92:95], v14, s[28:31], s64 offen offset:3072 sc1
    s_add_u32 s64, s64, 4096
    buffer_store_dwordx4 v[96:99], v14, s[28:31], s64 offen offset:0 sc1
    buffer_store_dwordx4 v[100:103], v14, s[28:31], s64 offen offset:1024 sc1
    buffer_store_dwordx4 v[104:107], v14, s[28:31], s64 offen offset:2048 sc1
    buffer_store_dwordx4 v[108:111], v14, s[28:31], s64 offen offset:3072 sc1
    s_add_u32 s64, s64, 4096
    buffer_store_dwordx4 v[112:115], v14, s[28:31], s64 offen offset:0 sc1
    buffer_store_dwordx4 v[116:119], v14, s[28:31], s64 offen offset:1024 sc1
    buffer_store_dwordx4 v[120:123], v14, s[28:31], s64 offen offset:2048 sc1
    buffer_store_dwordx4 v[124:127], v14, s[28:31], s64 offen offset:3072 sc1
BGL_NOTAB:
    s_lshl_b32 s49, 1, s50
    s_cmp_lt_u32 s50, 14
    s_cbranch_scc1 BGL_LOOP
    s_waitcnt vmcnt(0)
    v_mov_b32 v21, s49
    s_mov_b64 exec, 1
    ds_or_b32 v20, v21
    s_mov_b64 exec, -1
    s_cmp_eq_u32 s65, 0
    s_cbranch_scc1 BGL_NOFLG
    s_mov_b64 exec, 1
    buffer_store_dword v8, v2, s[28:31], s65 offen sc1
    s_mov_b64 exec, -1
BGL_NOFLG:
    s_lshr_b32 s34, s33, 1
    s_and_b32 s35, s33, 1
    s_cmp_eq_u32 s34, 0
    s_mov_b32 s37, 6815744
    s_cselect_b32 s36, 6291456, s37
    s_cselect_b32 s56, s41, s40
    s_xor_b32 s37, s36, 524288
    s_mov_b32 s52, s20
    s_mov_b32 s53, s21
    s_mov_b32 s54, 4194304
    s_mov_b32 s55, 0x20000
    v_and_b32 v6, 31, v0
    v_lshrrev_b32 v7, 5, v0
    s_lshl_b32 s47, s40, 1
    s_add_u32 s47, s47, s34
    s_lshl_b32 s48, s47, 16
    s_lshl_b32 s44, s35, 15
    s_add_u32 s48, s48, s44
    s_add_u32 s48, s48, 10485760
    s_lshl_b32 s47, s47, 6
    s_lshl_b32 s49, s35, 5
    s_add_u32 s47, s47, s49
    s_add_u32 s47, s47, 7503872
    v_and_b32 v15, 1, v0
    v_lshlrev_b32 v15, 4, v15
    s_lshl_b32 s44, s41, 16
    s_lshl_b32 s45, s35, 15
    s_add_u32 s44, s44, s45
    v_add_u32 v12, s44, v14
    v_mov_b32 v10, 1
    v_mov_b32 v11, 0
    s_lshl_b32 s45, s35, 12
    s_add_u32 s45, s45, 7471104
    s_add_u32 s46, s45, 32
    v_lshlrev_b32 v9, 6, v0
    v_mov_b64 v[144:145], 0
    v_mov_b64 v[146:147], 0
    v_mov_b64 v[148:149], 0
    v_mov_b64 v[150:151], 0
    v_mov_b64 v[152:153], 0
    v_mov_b64 v[154:155], 0
    v_mov_b64 v[156:157], 0
    v_mov_b64 v[158:159], 0
    s_lshl_b32 s57, s41, 2
    s_add_u32 s57, s57, s33
    s_lshl_b32 s58, s57, 16
    s_lshl_b32 s59, s40, 10
    s_add_u32 s58, s58, s59
    s_add_u32 s58, s58, 8388608
    s_add_u32 s59, s58, 0x8000
    v_mov_b64 v[16:17], -1
    v_mov_b64 v[18:19], -1
    s_lshl_b32 s57, s57, 5
    s_add_u32 s57, s57, s40
    buffer_store_dwordx4 v[16:19], v14, s[28:31], s58 offen sc1
    buffer_store_dwordx4 v[16:19], v14, s[28:31], s59 offen sc1
    s_lshl_b32 s57, s57, 4
    s_add_u32 s57, s57, 7569408
    s_mov_b32 s68, 65536
BG2_SP:
    buffer_load_dword v13, v9, s[28:31], s45 offen sc1
    s_sub_u32 s68, s68, 1
    s_waitcnt vmcnt(0)
    v_cmp_ne_u32 vcc, s27, v13
    s_cbranch_scc1 BG2_OK
    s_cbranch_vccnz BG2_SP
BG2_OK:
    v_mov_b32 v13, s27
    s_mov_b64 exec, 1
    buffer_store_dword v13, v11, s[28:31], s57 offen sc1
    s_mov_b64 exec, -1
    s_mov_b32 s68, 65536
BG3_SP:
    buffer_load_dword v13, v9, s[28:31], s46 offen sc1
    s_sub_u32 s68, s68, 1
    s_waitcnt vmcnt(0)
    v_cmp_ne_u32 vcc, s27, v13
    s_cbranch_scc1 BG3_OK
    s_cbranch_vccnz BG3_SP
BG3_OK:
    s_mov_b32 s68, 65536
BG4_SP:
    buffer_load_dword v13, v15, s[28:31], s47 offen sc1
    s_sub_u32 s68, s68, 1
    s_waitcnt vmcnt(0)
    v_cmp_ne_u32 vcc, s27, v13
    s_cbranch_scc1 BG4_OK
    s_cbranch_vccnz BG4_SP
BG4_OK:
    s_cmp_eq_u32 s56, 0
    s_cbranch_scc1 BG_FEXT
    buffer_load_dwordx4 v[16:19], v14, s[28:31], s48 offen offset:0 sc1
    buffer_load_dwordx4 v[20:23], v12, s[28:31], s36 offen offset:0 sc1
    buffer_load_dwordx4 v[24:27], v14, s[28:31], s48 offen offset:1024 sc1
    buffer_load_dwordx4 v[28:31], v12, s[28:31], s36 offen offset:1024 sc1
    buffer_load_dwordx4 v[32:35], v14, s[28:31], s48 offen offset:2048 sc1
    buffer_load_dwordx4 v[36:39], v12, s[28:31], s36 offen offset:2048 sc1
    buffer_load_dwordx4 v[40:43], v14, s[28:31], s48 offen offset:3072 sc1
    buffer_load_dwordx4 v[44:47], v12, s[28:31], s36 offen offset:3072 sc1
    s_add_u32 s48, s48, 4096
    s_add_u32 s36, s36, 4096
    buffer_load_dwordx4 v[48:51], v14, s[28:31], s48 offen offset:0 sc1
    buffer_load_dwordx4 v[52:55], v12, s[28:31], s36 offen offset:0 sc1
    buffer_load_dwordx4 v[56:59], v14, s[28:31], s48 offen offset:1024 sc1
    buffer_load_dwordx4 v[60:63], v12, s[28:31], s36 offen offset:1024 sc1
    buffer_load_dwordx4 v[64:67], v14, s[28:31], s48 offen offset:2048 sc1
    buffer_load_dwordx4 v[68:71], v12, s[28:31], s36 offen offset:2048 sc1
    buffer_load_dwordx4 v[72:75], v14, s[28:31], s48 offen offset:3072 sc1
    buffer_load_dwordx4 v[76:79], v12, s[28:31], s36 offen offset:3072 sc1
    s_add_u32 s48, s48, 4096
    s_add_u32 s36, s36, 4096
    buffer_load_dwordx4 v[80:83], v14, s[28:31], s48 offen offset:0 sc1
    buffer_load_dwordx4 v[84:87], v12, s[28:31], s36 offen offset:0 sc1
    buffer_load_dwordx4 v[88:91], v14, s[28:31], s48 offen offset:1024 sc1
    buffer_load_dwordx4 v[92:95], v12, s[28:31], s36 offen offset:1024 sc1
    buffer_load_dwordx4 v[96:99], v14, s[28:31], s48 offen offset:2048 sc1
    buffer_load_dwordx4 v[100:103], v12, s[28:31], s36 offen offset:2048 sc1
    buffer_load_dwordx4 v[104:107], v14, s[28:31], s48 offen offset:3072 sc1
    buffer_load_dwordx4 v[108:111], v12, s[28:31], s36 offen offset:3072 sc1
    s_add_u32 s48, s48, 4096
    s_add_u32 s36, s36, 4096
    s_waitcnt vmcnt(22)
    v_mfma_f32_32x32x16_bf16 v[128:143], v[16:19], v[20:23], 0
    buffer_load_dwordx4 v[16:19], v14, s[28:31], s48 offen offset:0 sc1
    buffer_load_dwordx4 v[20:23], v12, s[28:31], s36 offen offset:0 sc1
    s_waitcnt vmcnt(22)
    v_mfma_f32_32x32x16_bf16 v[128:143], v[24:27], v[28:31], v[128:143]
    buffer_load_dwordx4 v[24:27], v14, s[28:31], s48 offen offset:1024 sc1
    buffer_load_dwordx4 v[28:31], v12, s[28:31], s36 offen offset:1024 sc1
    s_waitcnt vmcnt(22)
    v_mfma_f32_32x32x16_bf16 v[128:143], v[32:35], v[36:39], v[128:143]
    buffer_load_dwordx4 v[32:35], v14, s[28:31], s48 offen offset:2048 sc1
    buffer_load_dwordx4 v[36:39], v12, s[28:31], s36 offen offset:2048 sc1
    s_waitcnt vmcnt(22)
    v_mfma_f32_32x32x16_bf16 v[128:143], v[40:43], v[44:47], v[128:143]
    buffer_load_dwordx4 v[40:43], v14, s[28:31], s48 offen offset:3072 sc1
    buffer_load_dwordx4 v[44:47], v12, s[28:31], s36 offen offset:3072 sc1
    s_add_u32 s48, s48, 4096
    s_add_u32 s36, s36, 4096
    s_waitcnt vmcnt(22)
    v_mfma_f32_32x32x16_bf16 v[128:143], v[48:51], v[52:55], v[128:143]
    buffer_load_dwordx4 v[48:51], v14, s[28:31], s48 offen offset:0 sc1
    buffer_load_dwordx4 v[52:55], v12, s[28:31], s36 offen offset:0 sc1
    s_waitcnt vmcnt(22)
    v_mfma_f32_32x32x16_bf16 v[128:143], v[56:59], v[60:63], v[128:143]
    buffer_load_dwordx4 v[56:59], v14, s[28:31], s48 offen offset:1024 sc1
    buffer_load_dwordx4 v[60:63], v12, s[28:31], s36 offen offset:1024 sc1
    s_waitcnt vmcnt(22)
    v_mfma_f32_32x32x16_bf16 v[128:143], v[64:67], v[68:71], v[128:143]
    buffer_load_dwordx4 v[64:67], v14, s[28:31], s48 offen offset:2048 sc1
    buffer_load_dwordx4 v[68:71], v12, s[28:31], s36 offen offset:2048 sc1
    s_waitcnt vmcnt(22)
    v_mfma_f32_32x32x16_bf16 v[128:143], v[72:75], v[76:79], v[128:143]
    buffer_load_dwordx4 v[72:75], v14, s[28:31], s48 offen offset:3072 sc1
    buffer_load_dwordx4 v[76:79], v12, s[28:31], s36 offen offset:3072 sc1
    s_add_u32 s48, s48, 4096
    s_add_u32 s36, s36, 4096
    s_waitcnt vmcnt(22)
    v_mfma_f32_32x32x16_bf16 v[128:143], v[80:83], v[84:87], v[128:143]
    buffer_load_dwordx4 v[80:83], v14, s[28:31], s48 offen offset:0 sc1
    buffer_load_dwordx4 v[84:87], v12, s[28:31], s36 offen offset:0 sc1
    s_waitcnt vmcnt(22)
    v_mfma_f32_32x32x16_bf16 v[128:143], v[88:91], v[92:95], v[128:143]
    buffer_load_dwordx4 v[88:91], v14, s[28:31], s48 offen offset:1024 sc1
    buffer_load_dwordx4 v[92:95], v12, s[28:31], s36 offen offset:1024 sc1
    s_waitcnt vmcnt(22)
    v_mfma_f32_32x32x16_bf16 v[128:143], v[96:99], v[100:103], v[128:143]
    buffer_load_dwordx4 v[96:99], v14, s[28:31], s48 offen offset:2048 sc1
    buffer_load_dwordx4 v[100:103], v12, s[28:31], s36 offen offset:2048 sc1
    s_waitcnt vmcnt(22)
    v_mfma_f32_32x32x16_bf16 v[128:143], v[104:107], v[108:111], v[128:143]
    buffer_load_dwordx4 v[104:107], v14, s[28:31], s48 offen offset:3072 sc1
    buffer_load_dwordx4 v[108:111], v12, s[28:31], s36 offen offset:3072 sc1
    s_add_u32 s48, s48, 4096
    s_add_u32 s36, s36, 4096
    s_waitcnt vmcnt(22)
    v_mfma_f32_32x32x16_bf16 v[128:143], v[16:19], v[20:23], v[128:143]
    buffer_load_dwordx4 v[16:19], v14, s[28:31], s48 offen offset:0 sc1
    buffer_load_dwordx4 v[20:23], v12, s[28:31], s36 offen offset:0 sc1
    s_waitcnt vmcnt(22)
    v_mfma_f32_32x32x16_bf16 v[128:143], v[24:27], v[28:31], v[128:143]
    buffer_load_dwordx4 v[24:27], v14, s[28:31], s48 offen offset:1024 sc1
    buffer_load_dwordx4 v[28:31], v12, s[28:31], s36 offen offset:1024 sc1
    s_waitcnt vmcnt(22)
    v_mfma_f32_32x32x16_bf16 v[128:143], v[32:35], v[36:39], v[128:143]
    buffer_load_dwordx4 v[32:35], v14, s[28:31], s48 offen offset:2048 sc1
    buffer_load_dwordx4 v[36:39], v12, s[28:31], s36 offen offset:2048 sc1
    s_waitcnt vmcnt(22)
    v_mfma_f32_32x32x16_bf16 v[128:143], v[40:43], v[44:47], v[128:143]
    buffer_load_dwordx4 v[40:43], v14, s[28:31], s48 offen offset:3072 sc1
    buffer_load_dwordx4 v[44:47], v12, s[28:31], s36 offen offset:3072 sc1
    s_add_u32 s48, s48, 4096
    s_add_u32 s36, s36, 4096
    s_waitcnt vmcnt(22)
    v_mfma_f32_32x32x16_bf16 v[128:143], v[48:51], v[52:55], v[128:143]
    buffer_load_dwordx4 v[48:51], v14, s[28:31], s48 offen offset:0 sc1
    buffer_load_dwordx4 v[52:55], v12, s[28:31], s36 offen offset:0 sc1
    s_waitcnt vmcnt(22)
    v_mfma_f32_32x32x16_bf16 v[128:143], v[56:59], v[60:63], v[128:143]
    buffer_load_dwordx4 v[56:59], v14, s[28:31], s48 offen offset:1024 sc1
    buffer_load_dwordx4 v[60:63], v12, s[28:31], s36 offen offset:1024 sc1
    s_waitcnt vmcnt(22)
    v_mfma_f32_32x32x16_bf16 v[128:143], v[64:67], v[68:71], v[128:143]
    buffer_load_dwordx4 v[64:67], v14, s[28:31], s48 offen offset:2048 sc1
    buffer_load_dwordx4 v[68:71], v12, s[28:31], s36 offen offset:2048 sc1
    s_waitcnt vmcnt(22)
    v_mfma_f32_32x32x16_bf16 v[128:143], v[72:75], v[76:79], v[128:143]
    buffer_load_dwordx4 v[72:75], v14, s[28:31], s48 offen offset:3072 sc1
    buffer_load_dwordx4 v[76:79], v12, s[28:31], s36 offen offset:3072 sc1
    s_add_u32 s48, s48, 4096
    s_add_u32 s36, s36, 4096
    s_waitcnt vmcnt(22)
    v_mfma_f32_32x32x16_bf16 v[128:143], v[80:83], v[84:87], v[128:143]
    s_waitcnt vmcnt(20)
    v_mfma_f32_32x32x16_bf16 v[128:143], v[88:91], v[92:95], v[128:143]
    s_waitcnt vmcnt(18)
    v_mfma_f32_32x32x16_bf16 v[128:143], v[96:99], v[100:103], v[128:143]
    s_waitcnt vmcnt(16)
    v_mfma_f32_32x32x16_bf16 v[128:143], v[104:107], v[108:111], v[128:143]
    s_waitcnt vmcnt(14)
    v_mfma_f32_32x32x16_bf16 v[128:143], v[16:19], v[20:23], v[128:143]
    s_waitcnt vmcnt(12)
    v_mfma_f32_32x32x16_bf16 v[128:143], v[24:27], v[28:31], v[128:143]
    s_waitcnt vmcnt(10)
    v_mfma_f32_32x32x16_bf16 v[128:143], v[32:35], v[36:39], v[128:143]
    s_waitcnt vmcnt(8)
    v_mfma_f32_32x32x16_bf16 v[128:143], v[40:43], v[44:47], v[128:143]
    s_waitcnt vmcnt(6)
    v_mfma_f32_32x32x16_bf16 v[128:143], v[48:51], v[52:55], v[128:143]
    s_waitcnt vmcnt(4)
    v_mfma_f32_32x32x16_bf16 v[128:143], v[56:59], v[60:63], v[128:143]
    s_waitcnt vmcnt(2)
    v_mfma_f32_32x32x16_bf16 v[128:143], v[64:67], v[68:71], v[128:143]
    s_waitcnt vmcnt(0)
    v_mfma_f32_32x32x16_bf16 v[128:143], v[72:75], v[76:79], v[128:143]
    s_branch BG_FDONE
BG_FEXT:
    buffer_load_dwordx4 v[16:19], v14, s[28:31], s48 offen offset:0 sc1
    buffer_load_dwordx4 v[20:23], v12, s[28:31], s36 offen offset:0 sc1
    buffer_load_dwordx4 v[24:27], v12, s[28:31], s37 offen offset:0 sc1
    buffer_load_dwordx4 v[28:31], v14, s[28:31], s48 offen offset:1024 sc1
    buffer_load_dwordx4 v[32:35], v12, s[28:31], s36 offen offset:1024 sc1
    buffer_load_dwordx4 v[36:39], v12, s[28:31], s37 offen offset:1024 sc1
    buffer_load_dwordx4 v[40:43], v14, s[28:31], s48 offen offset:2048 sc1
    buffer_load_dwordx4 v[44:47], v12, s[28:31], s36 offen offset:2048 sc1
    buffer_load_dwordx4 v[48:51], v12, s[28:31], s37 offen offset:2048 sc1
    buffer_load_dwordx4 v[52:55], v14, s[28:31], s48 offen offset:3072 sc1
    buffer_load_dwordx4 v[56:59], v12, s[28:31], s36 offen offset:3072 sc1
    buffer_load_dwordx4 v[60:63], v12, s[28:31], s37 offen offset:3072 sc1
    s_add_u32 s48, s48, 4096
    s_add_u32 s36, s36, 4096
    s_add_u32 s37, s37, 4096
    buffer_load_dwordx4 v[64:67], v14, s[28:31], s48 offen offset:0 sc1
    buffer_load_dwordx4 v[68:71], v12, s[28:31], s36 offen offset:0 sc1
    buffer_load_dwordx4 v[72:75], v12, s[28:31], s37 offen offset:0 sc1
    buffer_load_dwordx4 v[76:79], v14, s[28:31], s48 offen offset:1024 sc1
    buffer_load_dwordx4 v[80:83], v12, s[28:31], s36 offen offset:1024 sc1
    buffer_load_dwordx4 v[84:87], v12, s[28:31], s37 offen offset:1024 sc1
    buffer_load_dwordx4 v[88:91], v14, s[28:31], s48 offen offset:2048 sc1
    buffer_load_dwordx4 v[92:95], v12, s[28:31], s36 offen offset:2048 sc1
    buffer_load_dwordx4 v[96:99], v12, s[28:31], s37 offen offset:2048 sc1
    buffer_load_dwordx4 v[100:103], v14, s[28:31], s48 offen offset:3072 sc1
    buffer_load_dwordx4 v[104:107], v12, s[28:31], s36 offen offset:3072 sc1
    buffer_load_dwordx4 v[108:111], v12, s[28:31], s37 offen offset:3072 sc1
    s_add_u32 s48, s48, 4096
    s_add_u32 s36, s36, 4096
    s_add_u32 s37, s37, 4096
    s_waitcnt vmcnt(21)
    v_mfma_f32_32x32x16_bf16 v[128:143], v[16:19], v[20:23], 0
    v_mfma_f32_32x32x16_bf16 v[144:159], v[16:19], v[24:27], v[144:159]
    buffer_load_dwordx4 v[16:19], v14, s[28:31], s48 offen offset:0 sc1
    buffer_load_dwordx4 v[20:23], v12, s[28:31], s36 offen offset:0 sc1
    buffer_load_dwordx4 v[24:27], v12, s[28:31], s37 offen offset:0 sc1
    s_waitcnt vmcnt(21)
    v_mfma_f32_32x32x16_bf16 v[128:143], v[28:31], v[32:35], v[128:143]
    v_mfma_f32_32x32x16_bf16 v[144:159], v[28:31], v[36:39], v[144:159]
    buffer_load_dwordx4 v[28:31], v14, s[28:31], s48 offen offset:1024 sc1
    buffer_load_dwordx4 v[32:35], v12, s[28:31], s36 offen offset:1024 sc1
    buffer_load_dwordx4 v[36:39], v12, s[28:31], s37 offen offset:1024 sc1
    s_waitcnt vmcnt(21)
    v_mfma_f32_32x32x16_bf16 v[128:143], v[40:43], v[44:47], v[128:143]
    v_mfma_f32_32x32x16_bf16 v[144:159], v[40:43], v[48:51], v[144:159]
    buffer_load_dwordx4 v[40:43], v14, s[28:31], s48 offen offset:2048 sc1
    buffer_load_dwordx4 v[44:47], v12, s[28:31], s36 offen offset:2048 sc1
    buffer_load_dwordx4 v[48:51], v12, s[28:31], s37 offen offset:2048 sc1
    s_waitcnt vmcnt(21)
    v_mfma_f32_32x32x16_bf16 v[128:143], v[52:55], v[56:59], v[128:143]
    v_mfma_f32_32x32x16_bf16 v[144:159], v[52:55], v[60:63], v[144:159]
    buffer_load_dwordx4 v[52:55], v14, s[28:31], s48 offen offset:3072 sc1
    buffer_load_dwordx4 v[56:59], v12, s[28:31], s36 offen offset:3072 sc1
    buffer_load_dwordx4 v[60:63], v12, s[28:31], s37 offen offset:3072 sc1
    s_add_u32 s48, s48, 4096
    s_add_u32 s36, s36, 4096
    s_add_u32 s37, s37, 4096
    s_waitcnt vmcnt(21)
    v_mfma_f32_32x32x16_bf16 v[128:143], v[64:67], v[68:71], v[128:143]
    v_mfma_f32_32x32x16_bf16 v[144:159], v[64:67], v[72:75], v[144:159]
    buffer_load_dwordx4 v[64:67], v14, s[28:31], s48 offen offset:0 sc1
    buffer_load_dwordx4 v[68:71], v12, s[28:31], s36 offen offset:0 sc1
    buffer_load_dwordx4 v[72:75], v12, s[28:31], s37 offen offset:0 sc1
    s_waitcnt vmcnt(21)
    v_mfma_f32_32x32x16_bf16 v[128:143], v[76:79], v[80:83], v[128:143]
    v_mfma_f32_32x32x16_bf16 v[144:159], v[76:79], v[84:87], v[144:159]
    buffer_load_dwordx4 v[76:79], v14, s[28:31], s48 offen offset:1024 sc1
    buffer_load_dwordx4 v[80:83], v12, s[28:31], s36 offen offset:1024 sc1
    buffer_load_dwordx4 v[84:87], v12, s[28:31], s37 offen offset:1024 sc1
    s_waitcnt vmcnt(21)
    v_mfma_f32_32x32x16_bf16 v[128:143], v[88:91], v[92:95], v[128:143]
    v_mfma_f32_32x32x16_bf16 v[144:159], v[88:91], v[96:99], v[144:159]
    buffer_load_dwordx4 v[88:91], v14, s[28:31], s48 offen offset:2048 sc1
    buffer_load_dwordx4 v[92:95], v12, s[28:31], s36 offen offset:2048 sc1
    buffer_load_dwordx4 v[96:99], v12, s[28:31], s37 offen offset:2048 sc1
    s_waitcnt vmcnt(21)
    v_mfma_f32_32x32x16_bf16 v[128:143], v[100:103], v[104:107], v[128:143]
    v_mfma_f32_32x32x16_bf16 v[144:159], v[100:103], v[108:111], v[144:159]
    buffer_load_dwordx4 v[100:103], v14, s[28:31], s48 offen offset:3072 sc1
    buffer_load_dwordx4 v[104:107], v12, s[28:31], s36 offen offset:3072 sc1
    buffer_load_dwordx4 v[108:111], v12, s[28:31], s37 offen offset:3072 sc1
    s_add_u32 s48, s48, 4096
    s_add_u32 s36, s36, 4096
    s_add_u32 s37, s37, 4096
    s_waitcnt vmcnt(21)
    v_mfma_f32_32x32x16_bf16 v[128:143], v[16:19], v[20:23], v[128:143]
    v_mfma_f32_32x32x16_bf16 v[144:159], v[16:19], v[24:27], v[144:159]
    buffer_load_dwordx4 v[16:19], v14, s[28:31], s48 offen offset:0 sc1
    buffer_load_dwordx4 v[20:23], v12, s[28:31], s36 offen offset:0 sc1
    buffer_load_dwordx4 v[24:27], v12, s[28:31], s37 offen offset:0 sc1
    s_waitcnt vmcnt(21)
    v_mfma_f32_32x32x16_bf16 v[128:143], v[28:31], v[32:35], v[128:143]
    v_mfma_f32_32x32x16_bf16 v[144:159], v[28:31], v[36:39], v[144:159]
    buffer_load_dwordx4 v[28:31], v14, s[28:31], s48 offen offset:1024 sc1
    buffer_load_dwordx4 v[32:35], v12, s[28:31], s36 offen offset:1024 sc1
    buffer_load_dwordx4 v[36:39], v12, s[28:31], s37 offen offset:1024 sc1
    s_waitcnt vmcnt(21)
    v_mfma_f32_32x32x16_bf16 v[128:143], v[40:43], v[44:47], v[128:143]
    v_mfma_f32_32x32x16_bf16 v[144:159], v[40:43], v[48:51], v[144:159]
    buffer_load_dwordx4 v[40:43], v14, s[28:31], s48 offen offset:2048 sc1
    buffer_load_dwordx4 v[44:47], v12, s[28:31], s36 offen offset:2048 sc1
    buffer_load_dwordx4 v[48:51], v12, s[28:31], s37 offen offset:2048 sc1
    s_waitcnt vmcnt(21)
    v_mfma_f32_32x32x16_bf16 v[128:143], v[52:55], v[56:59], v[128:143]
    v_mfma_f32_32x32x16_bf16 v[144:159], v[52:55], v[60:63], v[144:159]
    buffer_load_dwordx4 v[52:55], v14, s[28:31], s48 offen offset:3072 sc1
    buffer_load_dwordx4 v[56:59], v12, s[28:31], s36 offen offset:3072 sc1
    buffer_load_dwordx4 v[60:63], v12, s[28:31], s37 offen offset:3072 sc1
    s_add_u32 s48, s48, 4096
    s_add_u32 s36, s36, 4096
    s_add_u32 s37, s37, 4096
    s_waitcnt vmcnt(21)
    v_mfma_f32_32x32x16_bf16 v[128:143], v[64:67], v[68:71], v[128:143]
    v_mfma_f32_32x32x16_bf16 v[144:159], v[64:67], v[72:75], v[144:159]
    buffer_load_dwordx4 v[64:67], v14, s[28:31], s48 offen offset:0 sc1
    buffer_load_dwordx4 v[68:71], v12, s[28:31], s36 offen offset:0 sc1
    buffer_load_dwordx4 v[72:75], v12, s[28:31], s37 offen offset:0 sc1
    s_waitcnt vmcnt(21)
    v_mfma_f32_32x32x16_bf16 v[128:143], v[76:79], v[80:83], v[128:143]
    v_mfma_f32_32x32x16_bf16 v[144:159], v[76:79], v[84:87], v[144:159]
    buffer_load_dwordx4 v[76:79], v14, s[28:31], s48 offen offset:1024 sc1
    buffer_load_dwordx4 v[80:83], v12, s[28:31], s36 offen offset:1024 sc1
    buffer_load_dwordx4 v[84:87], v12, s[28:31], s37 offen offset:1024 sc1
    s_waitcnt vmcnt(21)
    v_mfma_f32_32x32x16_bf16 v[128:143], v[88:91], v[92:95], v[128:143]
    v_mfma_f32_32x32x16_bf16 v[144:159], v[88:91], v[96:99], v[144:159]
    buffer_load_dwordx4 v[88:91], v14, s[28:31], s48 offen offset:2048 sc1
    buffer_load_dwordx4 v[92:95], v12, s[28:31], s36 offen offset:2048 sc1
    buffer_load_dwordx4 v[96:99], v12, s[28:31], s37 offen offset:2048 sc1
    s_waitcnt vmcnt(21)
    v_mfma_f32_32x32x16_bf16 v[128:143], v[100:103], v[104:107], v[128:143]
    v_mfma_f32_32x32x16_bf16 v[144:159], v[100:103], v[108:111], v[144:159]
    buffer_load_dwordx4 v[100:103], v14, s[28:31], s48 offen offset:3072 sc1
    buffer_load_dwordx4 v[104:107], v12, s[28:31], s36 offen offset:3072 sc1
    buffer_load_dwordx4 v[108:111], v12, s[28:31], s37 offen offset:3072 sc1
    s_add_u32 s48, s48, 4096
    s_add_u32 s36, s36, 4096
    s_add_u32 s37, s37, 4096
    s_waitcnt vmcnt(21)
    v_mfma_f32_32x32x16_bf16 v[128:143], v[16:19], v[20:23], v[128:143]
    v_mfma_f32_32x32x16_bf16 v[144:159], v[16:19], v[24:27], v[144:159]
    buffer_load_dwordx4 v[16:19], v14, s[28:31], s48 offen offset:0 sc1
    buffer_load_dwordx4 v[20:23], v12, s[28:31], s36 offen offset:0 sc1
    buffer_load_dwordx4 v[24:27], v12, s[28:31], s37 offen offset:0 sc1
    s_waitcnt vmcnt(21)
    v_mfma_f32_32x32x16_bf16 v[128:143], v[28:31], v[32:35], v[128:143]
    v_mfma_f32_32x32x16_bf16 v[144:159], v[28:31], v[36:39], v[144:159]
    buffer_load_dwordx4 v[28:31], v14, s[28:31], s48 offen offset:1024 sc1
    buffer_load_dwordx4 v[32:35], v12, s[28:31], s36 offen offset:1024 sc1
    buffer_load_dwordx4 v[36:39], v12, s[28:31], s37 offen offset:1024 sc1
    s_waitcnt vmcnt(21)
    v_mfma_f32_32x32x16_bf16 v[128:143], v[40:43], v[44:47], v[128:143]
    v_mfma_f32_32x32x16_bf16 v[144:159], v[40:43], v[48:51], v[144:159]
    buffer_load_dwordx4 v[40:43], v14, s[28:31], s48 offen offset:2048 sc1
    buffer_load_dwordx4 v[44:47], v12, s[28:31], s36 offen offset:2048 sc1
    buffer_load_dwordx4 v[48:51], v12, s[28:31], s37 offen offset:2048 sc1
    s_waitcnt vmcnt(21)
    v_mfma_f32_32x32x16_bf16 v[128:143], v[52:55], v[56:59], v[128:143]
    v_mfma_f32_32x32x16_bf16 v[144:159], v[52:55], v[60:63], v[144:159]
    buffer_load_dwordx4 v[52:55], v14, s[28:31], s48 offen offset:3072 sc1
    buffer_load_dwordx4 v[56:59], v12, s[28:31], s36 offen offset:3072 sc1
    buffer_load_dwordx4 v[60:63], v12, s[28:31], s37 offen offset:3072 sc1
    s_add_u32 s48, s48, 4096
    s_add_u32 s36, s36, 4096
    s_add_u32 s37, s37, 4096
    s_waitcnt vmcnt(21)
    v_mfma_f32_32x32x16_bf16 v[128:143], v[64:67], v[68:71], v[128:143]
    v_mfma_f32_32x32x16_bf16 v[144:159], v[64:67], v[72:75], v[144:159]
    buffer_load_dwordx4 v[64:67], v14, s[28:31], s48 offen offset:0 sc1
    buffer_load_dwordx4 v[68:71], v12, s[28:31], s36 offen offset:0 sc1
    buffer_load_dwordx4 v[72:75], v12, s[28:31], s37 offen offset:0 sc1
    s_waitcnt vmcnt(21)
    v_mfma_f32_32x32x16_bf16 v[128:143], v[76:79], v[80:83], v[128:143]
    v_mfma_f32_32x32x16_bf16 v[144:159], v[76:79], v[84:87], v[144:159]
    buffer_load_dwordx4 v[76:79], v14, s[28:31], s48 offen offset:1024 sc1
    buffer_load_dwordx4 v[80:83], v12, s[28:31], s36 offen offset:1024 sc1
    buffer_load_dwordx4 v[84:87], v12, s[28:31], s37 offen offset:1024 sc1
    s_waitcnt vmcnt(21)
    v_mfma_f32_32x32x16_bf16 v[128:143], v[88:91], v[92:95], v[128:143]
    v_mfma_f32_32x32x16_bf16 v[144:159], v[88:91], v[96:99], v[144:159]
    buffer_load_dwordx4 v[88:91], v14, s[28:31], s48 offen offset:2048 sc1
    buffer_load_dwordx4 v[92:95], v12, s[28:31], s36 offen offset:2048 sc1
    buffer_load_dwordx4 v[96:99], v12, s[28:31], s37 offen offset:2048 sc1
    s_waitcnt vmcnt(21)
    v_mfma_f32_32x32x16_bf16 v[128:143], v[100:103], v[104:107], v[128:143]
    v_mfma_f32_32x32x16_bf16 v[144:159], v[100:103], v[108:111], v[144:159]
    buffer_load_dwordx4 v[100:103], v14, s[28:31], s48 offen offset:3072 sc1
    buffer_load_dwordx4 v[104:107], v12, s[28:31], s36 offen offset:3072 sc1
    buffer_load_dwordx4 v[108:111], v12, s[28:31], s37 offen offset:3072 sc1
    s_add_u32 s48, s48, 4096
    s_add_u32 s36, s36, 4096
    s_add_u32 s37, s37, 4096
    s_waitcnt vmcnt(21)
    v_mfma_f32_32x32x16_bf16 v[128:143], v[16:19], v[20:23], v[128:143]
    v_mfma_f32_32x32x16_bf16 v[144:159], v[16:19], v[24:27], v[144:159]
    s_waitcnt vmcnt(18)
    v_mfma_f32_32x32x16_bf16 v[128:143], v[28:31], v[32:35], v[128:143]
    v_mfma_f32_32x32x16_bf16 v[144:159], v[28:31], v[36:39], v[144:159]
    s_waitcnt vmcnt(15)
    v_mfma_f32_32x32x16_bf16 v[128:143], v[40:43], v[44:47], v[128:143]
    v_mfma_f32_32x32x16_bf16 v[144:159], v[40:43], v[48:51], v[144:159]
    s_waitcnt vmcnt(12)
    v_mfma_f32_32x32x16_bf16 v[128:143], v[52:55], v[56:59], v[128:143]
    v_mfma_f32_32x32x16_bf16 v[144:159], v[52:55], v[60:63], v[144:159]
    s_waitcnt vmcnt(9)
    v_mfma_f32_32x32x16_bf16 v[128:143], v[64:67], v[68:71], v[128:143]
    v_mfma_f32_32x32x16_bf16 v[144:159], v[64:67], v[72:75], v[144:159]
    s_waitcnt vmcnt(6)
    v_mfma_f32_32x32x16_bf16 v[128:143], v[76:79], v[80:83], v[128:143]
    v_mfma_f32_32x32x16_bf16 v[144:159], v[76:79], v[84:87], v[144:159]
    s_waitcnt vmcnt(3)
    v_mfma_f32_32x32x16_bf16 v[128:143], v[88:91], v[92:95], v[128:143]
    v_mfma_f32_32x32x16_bf16 v[144:159], v[88:91], v[96:99], v[144:159]
    s_waitcnt vmcnt(0)
    v_mfma_f32_32x32x16_bf16 v[128:143], v[100:103], v[104:107], v[128:143]
    v_mfma_f32_32x32x16_bf16 v[144:159], v[100:103], v[108:111], v[144:159]
BG_FDONE:
    s_lshl_b32 s44, s41, 7
    v_lshl_add_u32 v12, v6, 2, s44
    s_mov_b32 s44, 7340032
    v_mov_b32 v13, 1024
    s_mov_b32 s69, s44
    s_mul_i32 s44, s33, 3072
    s_add_u32 s44, s44, 150784
    s_lshl_b32 s45, s35, 7
    s_lshl_b32 s46, s34, 8
    s_add_u32 s45, s45, s46
    s_add_u32 s45, s45, 163072
    v_lshlrev_b32 v3, 6, v7
    v_add_u32 v3, s45, v3
    v_lshl_add_u32 v4, v6, 2, s45
    s_nop 3
    s_sub_u32 s46, 3, s33
    s_and_b32 s46, s46, 3
    s_cmp_eq_u32 s46, 3
    s_cselect_b64 exec, 0, -1
    s_lshl_b32 s46, s46, 10
    s_add_u32 s46, s46, s44
    v_add_u32 v2, s46, v14
    ds_write_b128 v2, v[128:131]
    s_sub_u32 s46, 4, s33
    s_and_b32 s46, s46, 3
    s_cmp_eq_u32 s46, 3
    s_cselect_b64 exec, 0, -1
    s_lshl_b32 s46, s46, 10
    s_add_u32 s46, s46, s44
    v_add_u32 v2, s46, v14
    ds_write_b128 v2, v[132:135]
    s_sub_u32 s46, 5, s33
    s_and_b32 s46, s46, 3
    s_cmp_eq_u32 s46, 3
    s_cselect_b64 exec, 0, -1
    s_lshl_b32 s46, s46, 10
    s_add_u32 s46, s46, s44
    v_add_u32 v2, s46, v14
    ds_write_b128 v2, v[136:139]
    s_sub_u32 s46, 6, s33
    s_and_b32 s46, s46, 3
    s_cmp_eq_u32 s46, 3
    s_cselect_b64 exec, 0, -1
    s_lshl_b32 s46, s46, 10
    s_add_u32 s46, s46, s44
    v_add_u32 v2, s46, v14
    ds_write_b128 v2, v[140:143]
    s_mov_b64 exec, -1
    s_cmp_eq_u32 s34, 0
    s_cbranch_scc0 BG_XQ
    s_mov_b32 exec_lo, 1
    s_mov_b32 exec_hi, 1
    ds_write_b128 v3, v[144:147] offset:0
    ds_write_b128 v3, v[148:151] offset:16
    ds_write_b128 v3, v[152:155] offset:32
    ds_write_b128 v3, v[156:159] offset:48
    s_branch BG_XD
BG_XQ:
    s_mov_b32 exec_hi, 0
    ds_write_b32 v4, v144
BG_XD:
    s_mov_b64 exec, 1
    s_waitcnt lgkmcnt(0)
    ds_add_u32 v1, v10 offset:12
    s_mov_b64 exec, -1
    s_cmp_lt_u32 s33, 2
    s_cbranch_scc1 BG_M01
    s_cmp_eq_u32 s33, 2
    s_cbranch_scc1 BG_M2
    v_mov_b32 v20, v140
    v_mov_b32 v21, v141
    v_mov_b32 v22, v142
    v_mov_b32 v23, v143
    s_branch BG_MD
BG_M2:
    v_mov_b32 v20, v136
    v_mov_b32 v21, v137
    v_mov_b32 v22, v138
    v_mov_b32 v23, v139
    s_branch BG_MD
BG_M01:
    s_cmp_eq_u32 s33, 0
    s_cbranch_scc1 BG_M0
    v_mov_b32 v20, v132
    v_mov_b32 v21, v133
    v_mov_b32 v22, v134
    v_mov_b32 v23, v135
    s_branch BG_MD
BG_M0:
    v_mov_b32 v20, v128
    v_mov_b32 v21, v129
    v_mov_b32 v22, v130
    v_mov_b32 v23, v131
BG_MD:
    s_add_u32 s46, s33, 1
    s_and_b32 s46, s46, 3
    s_mul_i32 s46, s46, 3072
    s_add_u32 s46, s46, 152832
    v_add_u32 v41, s46, v14
    s_add_u32 s46, s33, 2
    s_and_b32 s46, s46, 3
    s_mul_i32 s46, s46, 3072
    s_add_u32 s46, s46, 151808
    v_add_u32 v42, s46, v14
    s_add_u32 s46, s33, 3
    s_and_b32 s46, s46, 3
    s_mul_i32 s46, s46, 3072
    s_add_u32 s46, s46, 150784
    v_add_u32 v43, s46, v14
    s_lshl_b32 s46, s33, 4
    s_add_u32 s46, s46, 163072
    v_lshlrev_b32 v3, 6, v7
    v_add_u32 v3, s46, v3
    v_lshlrev_b32 v4, 2, v6
    v_add_u32 v4, 163328, v4
BG_FSPIN:
    ds_read_b32 v5, v1 offset:12
    s_waitcnt lgkmcnt(0)
    v_readfirstlane_b32 s46, v5
    s_cmp_ge_u32 s46, 4
    s_cbranch_scc0 BG_FSPIN
    buffer_load_dword v16, v12, s[28:31], s69 offen sc1
    buffer_load_dword v17, v13, s[28:31], s69 offen sc1
    ds_read_b128 v[24:27], v41
    ds_read_b128 v[28:31], v42
    ds_read_b128 v[32:35], v43
    ds_read_b128 v[44:47], v3
    ds_read_b128 v[48:51], v3 offset:128
    ds_read_b32 v52, v4
    ds_read_b32 v53, v4 offset:128
    s_lshr_b32 s46, s40, 3
    s_lshl_b32 s47, s41, 2
    s_add_u32 s46, s46, s47
    s_lshl_b32 s46, s46, 9
    s_add_u32 s46, s46, 7569408
    v_lshlrev_b32 v2, 4, v6
    s_mov_b32 s68, 65536
BG5_SP:
    buffer_load_dword v3, v2, s[28:31], s46 offen sc1
    s_sub_u32 s68, s68, 1
    s_waitcnt vmcnt(0)
    v_cmp_ne_u32 vcc, s27, v3
    s_cbranch_scc1 BG5_OK
    s_cbranch_vccnz BG5_SP
BG5_OK:
    s_mov_b32 s48, s8
    s_mov_b32 s49, s9
    s_mov_b32 s50, 524288
    s_mov_b32 s51, 0x20000
    v_lshrrev_b32 v90, 3, v0
    v_and_b32 v91, 7, v0
    v_and_b32 v92, 2, v90
    v_lshlrev_b32 v92, 1, v92
    v_xor_b32 v91, v91, v92
    v_lshlrev_b32 v91, 4, v91
    v_lshl_add_u32 v90, v90, 10, v91
    s_and_b32 s44, s40, 7
    s_lshl_b32 s45, s44, 7
    s_lshl_b32 s69, s33, 17
    s_add_u32 s45, s45, s69
    buffer_load_dwordx4 v[96:99], v90, s[48:51], s45 offen
    s_add_u32 s45, s45, 8192
    buffer_load_dwordx4 v[100:103], v90, s[48:51], s45 offen
    s_add_u32 s45, s45, 8192
    buffer_load_dwordx4 v[104:107], v90, s[48:51], s45 offen
    s_add_u32 s45, s45, 8192
    buffer_load_dwordx4 v[108:111], v90, s[48:51], s45 offen
    s_add_u32 s45, s45, 8192
    buffer_load_dwordx4 v[112:115], v90, s[48:51], s45 offen
    s_add_u32 s45, s45, 8192
    buffer_load_dwordx4 v[116:119], v90, s[48:51], s45 offen
    s_add_u32 s45, s45, 8192
    buffer_load_dwordx4 v[120:123], v90, s[48:51], s45 offen
    s_add_u32 s45, s45, 8192
    buffer_load_dwordx4 v[124:127], v90, s[48:51], s45 offen
    s_add_u32 s45, s45, 8192
    buffer_load_dwordx4 v[128:131], v90, s[48:51], s45 offen
    s_add_u32 s45, s45, 8192
    buffer_load_dwordx4 v[132:135], v90, s[48:51], s45 offen
    s_add_u32 s45, s45, 8192
    buffer_load_dwordx4 v[136:139], v90, s[48:51], s45 offen
    s_add_u32 s45, s45, 8192
    buffer_load_dwordx4 v[140:143], v90, s[48:51], s45 offen
    s_add_u32 s45, s45, 8192
    buffer_load_dwordx4 v[144:147], v90, s[48:51], s45 offen
    s_add_u32 s45, s45, 8192
    buffer_load_dwordx4 v[148:151], v90, s[48:51], s45 offen
    s_add_u32 s45, s45, 8192
    buffer_load_dwordx4 v[152:155], v90, s[48:51], s45 offen
    s_add_u32 s45, s45, 8192
    buffer_load_dwordx4 v[156:159], v90, s[48:51], s45 offen
    s_add_u32 s45, s45, 8192
    s_lshl_b32 s69, s33, 14
    v_add_u32 v91, s69, v14
    s_lshr_b32 s69, s40, 3
    s_lshl_b32 s47, s41, 2
    s_add_u32 s69, s69, s47
    s_lshl_b32 s69, s69, 9
    s_add_u32 s69, s69, 7536640
    v_lshlrev_b32 v92, 3, v0
    s_waitcnt vmcnt(0) lgkmcnt(0)
    s_barrier
    ds_read_b32 v93, v1 offset:8
    s_waitcnt lgkmcnt(0)
    v_readfirstlane_b32 s47, v93
    s_cmp_eq_u32 s47, 0
    s_cbranch_scc1 BG_T1
    s_barrier
    s_barrier
BG_T1:
    ds_write_b128 v91, v[96:99] offset:0
    ds_write_b128 v91, v[100:103] offset:1024
    ds_write_b128 v91, v[104:107] offset:2048
    ds_write_b128 v91, v[108:111] offset:3072
    ds_write_b128 v91, v[112:115] offset:4096
    ds_write_b128 v91, v[116:119] offset:5120
    ds_write_b128 v91, v[120:123] offset:6144
    ds_write_b128 v91, v[124:127] offset:7168
    ds_write_b128 v91, v[128:131] offset:8192
    ds_write_b128 v91, v[132:135] offset:9216
    ds_write_b128 v91, v[136:139] offset:10240
    ds_write_b128 v91, v[140:143] offset:11264
    ds_write_b128 v91, v[144:147] offset:12288
    ds_write_b128 v91, v[148:151] offset:13312
    ds_write_b128 v91, v[152:155] offset:14336
    ds_write_b128 v91, v[156:159] offset:15360
    s_waitcnt lgkmcnt(0)
    s_barrier
    s_setprio 0
    s_and_b32 s46, s33, 1
    s_cmp_eq_u32 s46, 0
    s_cselect_b64 s[60:61], -1, 0
    s_cmp_eq_u32 s34, 0
    s_cselect_b64 s[62:63], -1, 0
    s_cmp_eq_u32 s41, 0
    s_cselect_b32 s64, 1, 0
    s_mov_b32 s65, s64
    s_or_b32 s46, s40, s33
    s_cmp_eq_u32 s46, 0
    s_cselect_b32 s66, -1, 0
    s_mov_b32 s67, 0
    s_lshl_b32 s46, s41, 5
    v_add_u32 v2, s46, v6
    v_sub_u32 v3, 512, v2
    v_mov_b32 v4, 256
    v_cndmask_b32 v3, v3, v4, s[64:65]
    v_lshlrev_b32 v2, 1, v2
    v_lshlrev_b32 v3, 1, v3
    v_add_u32 v2, 1024, v2
    v_add_u32 v3, 1024, v3
    s_lshl_b32 s46, s40, 5
    s_lshl_b32 s47, s33, 3
    s_add_u32 s46, s46, s47
    v_lshl_add_u32 v4, v7, 2, s46
    v_sub_u32 v5, 2045, v4
    v_lshl_add_u32 v8, v4, 11, v2
    v_lshl_add_u32 v9, v4, 11, v3
    v_lshl_add_u32 v10, v5, 11, v2
    v_lshl_add_u32 v11, v5, 11, v3
    v_mov_b32 v4, 1021
    v_cndmask_b32 v5, v5, v4, s[66:67]
    v_lshl_add_u32 v12, v5, 11, v2
    v_lshl_add_u32 v13, v5, 11, v3
    s_waitcnt vmcnt(0) lgkmcnt(0)
    v_cndmask_b32 v36, v32, v24, s[60:61]
    v_cndmask_b32 v37, v24, v32, s[60:61]
    v_add_f32 v36, v36, v20
    v_add_f32 v37, v37, v28
    v_cndmask_b32 v20, v37, v36, s[62:63]
    v_cndmask_b32 v24, v36, v37, s[62:63]
    v_add_f32 v44, v44, v48
    v_add_f32 v20, v20, v16
    v_add_f32 v44, v44, v17
    v_cndmask_b32 v36, v33, v25, s[60:61]
    v_cndmask_b32 v37, v25, v33, s[60:61]
    v_add_f32 v36, v36, v21
    v_add_f32 v37, v37, v29
    v_cndmask_b32 v21, v37, v36, s[62:63]
    v_cndmask_b32 v25, v36, v37, s[62:63]
    v_add_f32 v45, v45, v49
    v_sub_f32 v21, v21, v16
    v_sub_f32 v45, v45, v17
    v_cndmask_b32 v36, v34, v26, s[60:61]
    v_cndmask_b32 v37, v26, v34, s[60:61]
    v_add_f32 v36, v36, v22
    v_add_f32 v37, v37, v30
    v_cndmask_b32 v22, v37, v36, s[62:63]
    v_cndmask_b32 v26, v36, v37, s[62:63]
    v_add_f32 v46, v46, v50
    v_add_f32 v22, v22, v16
    v_add_f32 v46, v46, v17
    v_cndmask_b32 v36, v35, v27, s[60:61]
    v_cndmask_b32 v37, v27, v35, s[60:61]
    v_add_f32 v36, v36, v23
    v_add_f32 v37, v37, v31
    v_cndmask_b32 v23, v37, v36, s[62:63]
    v_cndmask_b32 v27, v36, v37, s[62:63]
    v_add_f32 v47, v47, v51
    v_sub_f32 v23, v23, v16
    v_sub_f32 v47, v47, v17
    v_add_f32 v52, v52, v53
    v_add_f32 v52, v52, v16
    v_add_f32 v53, v24, v17
    v_cndmask_b32 v24, v24, 0, s[66:67]
    v_cndmask_b32 v53, v52, v53, s[64:65]
    v_cndmask_b32 v24, v24, 0, s[64:65]
    v_sub_f32 v56, v20, v24
    v_add_f32 v57, v20, v24
    v_cndmask_b32 v58, v57, v44, s[64:65]
    v_cndmask_b32 v59, v56, v44, s[64:65]
    v_cndmask_b32 v57, v57, v52, s[66:67]
    v_cndmask_b32 v59, v59, v53, s[66:67]
    v_cvt_pk_bf16_f32 v60, v56, v57
    v_cvt_pk_bf16_f32 v61, v58, v59
    v_cndmask_b32 v25, v25, 0, s[64:65]
    v_sub_f32 v64, v21, v25
    v_add_f32 v65, v21, v25
    v_cndmask_b32 v66, v65, v45, s[64:65]
    v_cndmask_b32 v67, v64, v45, s[64:65]
    v_cvt_pk_bf16_f32 v68, v64, v65
    v_cvt_pk_bf16_f32 v69, v66, v67
    v_cndmask_b32 v26, v26, 0, s[64:65]
    v_sub_f32 v72, v22, v26
    v_add_f32 v73, v22, v26
    v_cndmask_b32 v74, v73, v46, s[64:65]
    v_cndmask_b32 v75, v72, v46, s[64:65]
    v_cvt_pk_bf16_f32 v76, v72, v73
    v_cvt_pk_bf16_f32 v77, v74, v75
    v_cndmask_b32 v27, v27, 0, s[64:65]
    v_sub_f32 v80, v23, v27
    v_add_f32 v81, v23, v27
    v_cndmask_b32 v82, v81, v47, s[64:65]
    v_cndmask_b32 v83, v80, v47, s[64:65]
    v_cvt_pk_bf16_f32 v84, v80, v81
    v_cvt_pk_bf16_f32 v85, v82, v83
    s_barrier
    s_mov_b32 s46, 0
    s_mov_b32 s47, 6144
    buffer_store_short v60, v8, s[52:55], s46 offen
    buffer_store_short_d16_hi v60, v12, s[52:55], s47 offen
    buffer_store_short v61, v9, s[52:55], s46 offen
    buffer_store_short_d16_hi v61, v13, s[52:55], s47 offen
    s_mov_b32 s46, 2048
    s_mov_b32 s47, 4096
    buffer_store_short v68, v8, s[52:55], s46 offen
    buffer_store_short_d16_hi v68, v10, s[52:55], s47 offen
    buffer_store_short v69, v9, s[52:55], s46 offen
    buffer_store_short_d16_hi v69, v11, s[52:55], s47 offen
    s_mov_b32 s46, 4096
    s_mov_b32 s47, 2048
    buffer_store_short v76, v8, s[52:55], s46 offen
    buffer_store_short_d16_hi v76, v10, s[52:55], s47 offen
    buffer_store_short v77, v9, s[52:55], s46 offen
    buffer_store_short_d16_hi v77, v11, s[52:55], s47 offen
    s_mov_b32 s46, 6144
    s_mov_b32 s47, 0
    buffer_store_short v84, v8, s[52:55], s46 offen
    buffer_store_short_d16_hi v84, v10, s[52:55], s47 offen
    buffer_store_short v85, v9, s[52:55], s46 offen
    buffer_store_short_d16_hi v85, v11, s[52:55], s47 offen
    s_endpgm
    .p2align 6
K_MAIN:
    s_mov_b32 s66, 0
    v_mov_b32 v142, 0
    s_cmp_eq_u32 s42, 3
    s_cbranch_scc0 K1_GEMM
    s_waitcnt lgkmcnt(0)
    s_mov_b32 s28, s24
    s_mov_b32 s29, s25
    s_mov_b32 s30, 14680064
    s_mov_b32 s31, 0x20000
    s_barrier
    s_branch K1_DONE
K1_GEMM:
    s_and_b32 s57, s26, 1
    s_lshr_b32 s58, s26, 1
    v_and_b32 v6, 31, v0
    v_lshrrev_b32 v7, 5, v0
    s_lshl_b32 s49, s57, 5
    v_add_u32 v8, s49, v6
    v_bfe_u32 v9, v8, 1, 3
    v_xor_b32 v9, v9, v7
    v_xor_b32 v10, 0, v9
    v_lshlrev_b32 v10, 4, v10
    v_lshl_add_u32 v96, v8, 7, v10
    v_add_u32 v100, 0x10000, v96
    v_xor_b32 v10, 2, v9
    v_lshlrev_b32 v10, 4, v10
    v_lshl_add_u32 v97, v8, 7, v10
    v_add_u32 v101, 0x10000, v97
    v_xor_b32 v10, 4, v9
    v_lshlrev_b32 v10, 4, v10
    v_lshl_add_u32 v98, v8, 7, v10
    v_add_u32 v102, 0x10000, v98
    v_xor_b32 v10, 6, v9
    v_lshlrev_b32 v10, 4, v10
    v_lshl_add_u32 v99, v8, 7, v10
    v_add_u32 v103, 0x10000, v99
    v_bfe_u32 v8, v0, 2, 2
    v_lshl_add_u32 v9, v7, 3, v8
    v_bfe_u32 v10, v0, 4, 1
    v_lshlrev_b32 v10, 1, v10
    v_bfe_u32 v11, v0, 1, 1
    v_add_u32 v10, v10, v11
    s_lshl_b32 s49, s58, 2
    v_add_u32 v10, s49, v10
    v_lshlrev_b32 v8, 2, v8
    v_xor_b32 v10, v10, v8
    v_lshlrev_b32 v10, 4, v10
    v_lshl_add_u32 v10, v9, 8, v10
    v_and_b32 v11, 1, v0
    v_lshl_add_u32 v104, v11, 3, v10
    v_add_u32 v105, 0x10000, v104
    s_waitcnt lgkmcnt(0)
    s_mov_b32 s28, s24
    s_mov_b32 s29, s25
    s_mov_b32 s30, 14680064
    s_mov_b32 s31, 0x20000
    s_lshl_b32 s60, s41, 3
    s_lshl_b32 s61, s58, 1
    s_add_u32 s60, s60, s61
    s_lshl_b32 s60, s60, 6
    s_lshl_b32 s61, s40, 2
    s_add_u32 s61, s61, s57
    s_add_u32 s60, s60, s61
    s_lshl_b32 s67, s41, 2
    s_add_u32 s67, s67, s42
    s_lshl_b32 s67, s67, 4
    s_add_u32 s67, s67, s40
    s_lshl_b32 s67, s67, 6
    s_add_u32 s67, s67, 7405568
    s_and_b32 s66, s40, 3
    s_cmp_eq_u32 s42, 0
    s_cselect_b32 s66, 0, s66
    s_cmp_ge_u32 s42, 2
    s_cbranch_scc1 K1_LOOP_XW
    s_barrier
    ds_read_b128 v[16:19], v96 offset:0
    ds_read_b64_tr_b16 v[24:25], v104 offset:16384
    ds_read_b64_tr_b16 v[26:27], v104 offset:17408
    ds_read_b128 v[20:23], v96 offset:8192
    ds_read_b128 v[28:31], v97 offset:0
    ds_read_b64_tr_b16 v[36:37], v104 offset:20480
    ds_read_b64_tr_b16 v[38:39], v104 offset:21504
    ds_read_b128 v[32:35], v97 offset:8192
    ds_read_b128 v[40:43], v98 offset:0
    ds_read_b64_tr_b16 v[48:49], v104 offset:24576
    ds_read_b64_tr_b16 v[50:51], v104 offset:25600
    ds_read_b128 v[44:47], v98 offset:8192
    s_waitcnt lgkmcnt(8)
    v_mfma_f32_32x32x16_bf16 v[64:79], v[24:27], v[16:19], 0
    v_mfma_f32_32x32x16_bf16 v[80:95], v[24:27], v[20:23], 0
    ds_read_b128 v[52:55], v99 offset:0
    ds_read_b64_tr_b16 v[60:61], v104 offset:28672
    ds_read_b64_tr_b16 v[62:63], v104 offset:29696
    ds_read_b128 v[56:59], v99 offset:8192
    s_waitcnt lgkmcnt(8)
    v_mfma_f32_32x32x16_bf16 v[64:79], v[36:39], v[28:31], v[64:79]
    v_mfma_f32_32x32x16_bf16 v[80:95], v[36:39], v[32:35], v[80:95]
    s_barrier
    ds_read_b128 v[16:19], v96 offset:32768
    ds_read_b64_tr_b16 v[24:25], v104 offset:49152
    ds_read_b64_tr_b16 v[26:27], v104 offset:50176
    ds_read_b128 v[20:23], v96 offset:40960
    s_waitcnt lgkmcnt(8)
    v_mfma_f32_32x32x16_bf16 v[64:79], v[48:51], v[40:43], v[64:79]
    v_mfma_f32_32x32x16_bf16 v[80:95], v[48:51], v[44:47], v[80:95]
    ds_read_b128 v[28:31], v97 offset:32768
    ds_read_b64_tr_b16 v[36:37], v104 offset:53248
    ds_read_b64_tr_b16 v[38:39], v104 offset:54272
    ds_read_b128 v[32:35], v97 offset:40960
    s_waitcnt lgkmcnt(8)
    v_mfma_f32_32x32x16_bf16 v[64:79], v[60:63], v[52:55], v[64:79]
    v_mfma_f32_32x32x16_bf16 v[80:95], v[60:63], v[56:59], v[80:95]
    ds_read_b128 v[40:43], v98 offset:32768
    ds_read_b64_tr_b16 v[48:49], v104 offset:57344
    ds_read_b64_tr_b16 v[50:51], v104 offset:58368
    ds_read_b128 v[44:47], v98 offset:40960
    s_waitcnt lgkmcnt(8)
    v_mfma_f32_32x32x16_bf16 v[64:79], v[24:27], v[16:19], v[64:79]
    v_mfma_f32_32x32x16_bf16 v[80:95], v[24:27], v[20:23], v[80:95]
    ds_read_b128 v[52:55], v99 offset:32768
    ds_read_b64_tr_b16 v[60:61], v104 offset:61440
    ds_read_b64_tr_b16 v[62:63], v104 offset:62464
    ds_read_b128 v[56:59], v99 offset:40960
    s_waitcnt lgkmcnt(8)
    v_mfma_f32_32x32x16_bf16 v[64:79], v[36:39], v[28:31], v[64:79]
    v_mfma_f32_32x32x16_bf16 v[80:95], v[36:39], v[32:35], v[80:95]
    s_barrier
    ds_read_b128 v[16:19], v100 offset:0
    ds_read_b64_tr_b16 v[24:25], v105 offset:16384
    ds_read_b64_tr_b16 v[26:27], v105 offset:17408
    ds_read_b128 v[20:23], v100 offset:8192
    s_waitcnt lgkmcnt(8)
    v_mfma_f32_32x32x16_bf16 v[64:79], v[48:51], v[40:43], v[64:79]
    v_mfma_f32_32x32x16_bf16 v[80:95], v[48:51], v[44:47], v[80:95]
    ds_read_b128 v[28:31], v101 offset:0
    ds_read_b64_tr_b16 v[36:37], v105 offset:20480
    ds_read_b64_tr_b16 v[38:39], v105 offset:21504
    ds_read_b128 v[32:35], v101 offset:8192
    s_waitcnt lgkmcnt(8)
    v_mfma_f32_32x32x16_bf16 v[64:79], v[60:63], v[52:55], v[64:79]
    v_mfma_f32_32x32x16_bf16 v[80:95], v[60:63], v[56:59], v[80:95]
    ds_read_b128 v[40:43], v102 offset:0
    ds_read_b64_tr_b16 v[48:49], v105 offset:24576
    ds_read_b64_tr_b16 v[50:51], v105 offset:25600
    ds_read_b128 v[44:47], v102 offset:8192
    s_waitcnt lgkmcnt(8)
    v_mfma_f32_32x32x16_bf16 v[64:79], v[24:27], v[16:19], v[64:79]
    v_mfma_f32_32x32x16_bf16 v[80:95], v[24:27], v[20:23], v[80:95]
    ds_read_b128 v[52:55], v103 offset:0
    ds_read_b64_tr_b16 v[60:61], v105 offset:28672
    ds_read_b64_tr_b16 v[62:63], v105 offset:29696
    ds_read_b128 v[56:59], v103 offset:8192
    s_waitcnt lgkmcnt(8)
    v_mfma_f32_32x32x16_bf16 v[64:79], v[36:39], v[28:31], v[64:79]
    v_mfma_f32_32x32x16_bf16 v[80:95], v[36:39], v[32:35], v[80:95]
    s_barrier
    ds_read_b128 v[16:19], v100 offset:32768
    ds_read_b64_tr_b16 v[24:25], v105 offset:49152
    ds_read_b64_tr_b16 v[26:27], v105 offset:50176
    ds_read_b128 v[20:23], v100 offset:40960
    s_waitcnt lgkmcnt(8)
    v_mfma_f32_32x32x16_bf16 v[64:79], v[48:51], v[40:43], v[64:79]
    v_mfma_f32_32x32x16_bf16 v[80:95], v[48:51], v[44:47], v[80:95]
    ds_read_b128 v[28:31], v101 offset:32768
    ds_read_b64_tr_b16 v[36:37], v105 offset:53248
    ds_read_b64_tr_b16 v[38:39], v105 offset:54272
    ds_read_b128 v[32:35], v101 offset:40960
    s_waitcnt lgkmcnt(8)
    v_mfma_f32_32x32x16_bf16 v[64:79], v[60:63], v[52:55], v[64:79]
    v_mfma_f32_32x32x16_bf16 v[80:95], v[60:63], v[56:59], v[80:95]
    ds_read_b128 v[40:43], v102 offset:32768
    ds_read_b64_tr_b16 v[48:49], v105 offset:57344
    ds_read_b64_tr_b16 v[50:51], v105 offset:58368
    ds_read_b128 v[44:47], v102 offset:40960
    s_waitcnt lgkmcnt(8)
    v_mfma_f32_32x32x16_bf16 v[64:79], v[24:27], v[16:19], v[64:79]
    v_mfma_f32_32x32x16_bf16 v[80:95], v[24:27], v[20:23], v[80:95]
    ds_read_b128 v[52:55], v103 offset:32768
    ds_read_b64_tr_b16 v[60:61], v105 offset:61440
    ds_read_b64_tr_b16 v[62:63], v105 offset:62464
    ds_read_b128 v[56:59], v103 offset:40960
    s_waitcnt lgkmcnt(8)
    v_mfma_f32_32x32x16_bf16 v[64:79], v[36:39], v[28:31], v[64:79]
    v_mfma_f32_32x32x16_bf16 v[80:95], v[36:39], v[32:35], v[80:95]
    s_barrier
    ds_read_b128 v[16:19], v96 offset:0
    ds_read_b64_tr_b16 v[24:25], v104 offset:16384
    ds_read_b64_tr_b16 v[26:27], v104 offset:17408
    ds_read_b128 v[20:23], v96 offset:8192
    s_waitcnt lgkmcnt(8)
    v_mfma_f32_32x32x16_bf16 v[64:79], v[48:51], v[40:43], v[64:79]
    v_mfma_f32_32x32x16_bf16 v[80:95], v[48:51], v[44:47], v[80:95]
    ds_read_b128 v[28:31], v97 offset:0
    ds_read_b64_tr_b16 v[36:37], v104 offset:20480
    ds_read_b64_tr_b16 v[38:39], v104 offset:21504
    ds_read_b128 v[32:35], v97 offset:8192
    s_waitcnt lgkmcnt(8)
    v_mfma_f32_32x32x16_bf16 v[64:79], v[60:63], v[52:55], v[64:79]
    v_mfma_f32_32x32x16_bf16 v[80:95], v[60:63], v[56:59], v[80:95]
    ds_read_b128 v[40:43], v98 offset:0
    ds_read_b64_tr_b16 v[48:49], v104 offset:24576
    ds_read_b64_tr_b16 v[50:51], v104 offset:25600
    ds_read_b128 v[44:47], v98 offset:8192
    s_waitcnt lgkmcnt(8)
    v_mfma_f32_32x32x16_bf16 v[64:79], v[24:27], v[16:19], v[64:79]
    v_mfma_f32_32x32x16_bf16 v[80:95], v[24:27], v[20:23], v[80:95]
    ds_read_b128 v[52:55], v99 offset:0
    ds_read_b64_tr_b16 v[60:61], v104 offset:28672
    ds_read_b64_tr_b16 v[62:63], v104 offset:29696
    ds_read_b128 v[56:59], v99 offset:8192
    s_waitcnt lgkmcnt(8)
    v_mfma_f32_32x32x16_bf16 v[64:79], v[36:39], v[28:31], v[64:79]
    v_mfma_f32_32x32x16_bf16 v[80:95], v[36:39], v[32:35], v[80:95]
    s_barrier
    ds_read_b128 v[16:19], v96 offset:32768
    ds_read_b64_tr_b16 v[24:25], v104 offset:49152
    ds_read_b64_tr_b16 v[26:27], v104 offset:50176
    ds_read_b128 v[20:23], v96 offset:40960
    s_waitcnt lgkmcnt(8)
    v_mfma_f32_32x32x16_bf16 v[64:79], v[48:51], v[40:43], v[64:79]
    v_mfma_f32_32x32x16_bf16 v[80:95], v[48:51], v[44:47], v[80:95]
    ds_read_b128 v[28:31], v97 offset:32768
    ds_read_b64_tr_b16 v[36:37], v104 offset:53248
    ds_read_b64_tr_b16 v[38:39], v104 offset:54272
    ds_read_b128 v[32:35], v97 offset:40960
    s_waitcnt lgkmcnt(8)
    v_mfma_f32_32x32x16_bf16 v[64:79], v[60:63], v[52:55], v[64:79]
    v_mfma_f32_32x32x16_bf16 v[80:95], v[60:63], v[56:59], v[80:95]
    ds_read_b128 v[40:43], v98 offset:32768
    ds_read_b64_tr_b16 v[48:49], v104 offset:57344
    ds_read_b64_tr_b16 v[50:51], v104 offset:58368
    ds_read_b128 v[44:47], v98 offset:40960
    s_waitcnt lgkmcnt(8)
    v_mfma_f32_32x32x16_bf16 v[64:79], v[24:27], v[16:19], v[64:79]
    v_mfma_f32_32x32x16_bf16 v[80:95], v[24:27], v[20:23], v[80:95]
    ds_read_b128 v[52:55], v99 offset:32768
    ds_read_b64_tr_b16 v[60:61], v104 offset:61440
    ds_read_b64_tr_b16 v[62:63], v104 offset:62464
    ds_read_b128 v[56:59], v99 offset:40960
    s_waitcnt lgkmcnt(8)
    v_mfma_f32_32x32x16_bf16 v[64:79], v[36:39], v[28:31], v[64:79]
    v_mfma_f32_32x32x16_bf16 v[80:95], v[36:39], v[32:35], v[80:95]
    s_barrier
    ds_read_b128 v[16:19], v100 offset:0
    ds_read_b64_tr_b16 v[24:25], v105 offset:16384
    ds_read_b64_tr_b16 v[26:27], v105 offset:17408
    ds_read_b128 v[20:23], v100 offset:8192
    s_waitcnt lgkmcnt(8)
    v_mfma_f32_32x32x16_bf16 v[64:79], v[48:51], v[40:43], v[64:79]
    v_mfma_f32_32x32x16_bf16 v[80:95], v[48:51], v[44:47], v[80:95]
    ds_read_b128 v[28:31], v101 offset:0
    ds_read_b64_tr_b16 v[36:37], v105 offset:20480
    ds_read_b64_tr_b16 v[38:39], v105 offset:21504
    ds_read_b128 v[32:35], v101 offset:8192
    s_waitcnt lgkmcnt(8)
    v_mfma_f32_32x32x16_bf16 v[64:79], v[60:63], v[52:55], v[64:79]
    v_mfma_f32_32x32x16_bf16 v[80:95], v[60:63], v[56:59], v[80:95]
    ds_read_b128 v[40:43], v102 offset:0
    ds_read_b64_tr_b16 v[48:49], v105 offset:24576
    ds_read_b64_tr_b16 v[50:51], v105 offset:25600
    ds_read_b128 v[44:47], v102 offset:8192
    s_waitcnt lgkmcnt(8)
    v_mfma_f32_32x32x16_bf16 v[64:79], v[24:27], v[16:19], v[64:79]
    v_mfma_f32_32x32x16_bf16 v[80:95], v[24:27], v[20:23], v[80:95]
    ds_read_b128 v[52:55], v103 offset:0
    ds_read_b64_tr_b16 v[60:61], v105 offset:28672
    ds_read_b64_tr_b16 v[62:63], v105 offset:29696
    ds_read_b128 v[56:59], v103 offset:8192
    s_waitcnt lgkmcnt(8)
    v_mfma_f32_32x32x16_bf16 v[64:79], v[36:39], v[28:31], v[64:79]
    v_mfma_f32_32x32x16_bf16 v[80:95], v[36:39], v[32:35], v[80:95]
    s_barrier
    ds_read_b128 v[16:19], v100 offset:32768
    ds_read_b64_tr_b16 v[24:25], v105 offset:49152
    ds_read_b64_tr_b16 v[26:27], v105 offset:50176
    ds_read_b128 v[20:23], v100 offset:40960
    s_waitcnt lgkmcnt(8)
    v_mfma_f32_32x32x16_bf16 v[64:79], v[48:51], v[40:43], v[64:79]
    v_mfma_f32_32x32x16_bf16 v[80:95], v[48:51], v[44:47], v[80:95]
    ds_read_b128 v[28:31], v101 offset:32768
    ds_read_b64_tr_b16 v[36:37], v105 offset:53248
    ds_read_b64_tr_b16 v[38:39], v105 offset:54272
    ds_read_b128 v[32:35], v101 offset:40960
    s_waitcnt lgkmcnt(8)
    v_mfma_f32_32x32x16_bf16 v[64:79], v[60:63], v[52:55], v[64:79]
    v_mfma_f32_32x32x16_bf16 v[80:95], v[60:63], v[56:59], v[80:95]
    ds_read_b128 v[40:43], v102 offset:32768
    ds_read_b64_tr_b16 v[48:49], v105 offset:57344
    ds_read_b64_tr_b16 v[50:51], v105 offset:58368
    ds_read_b128 v[44:47], v102 offset:40960
    s_waitcnt lgkmcnt(8)
    v_mfma_f32_32x32x16_bf16 v[64:79], v[24:27], v[16:19], v[64:79]
    v_mfma_f32_32x32x16_bf16 v[80:95], v[24:27], v[20:23], v[80:95]
    ds_read_b128 v[52:55], v103 offset:32768
    ds_read_b64_tr_b16 v[60:61], v105 offset:61440
    ds_read_b64_tr_b16 v[62:63], v105 offset:62464
    ds_read_b128 v[56:59], v103 offset:40960
    s_waitcnt lgkmcnt(8)
    v_mfma_f32_32x32x16_bf16 v[64:79], v[36:39], v[28:31], v[64:79]
    v_mfma_f32_32x32x16_bf16 v[80:95], v[36:39], v[32:35], v[80:95]
    s_waitcnt lgkmcnt(4)
    v_mfma_f32_32x32x16_bf16 v[64:79], v[48:51], v[40:43], v[64:79]
    v_mfma_f32_32x32x16_bf16 v[80:95], v[48:51], v[44:47], v[80:95]
    s_waitcnt lgkmcnt(0)
    v_mfma_f32_32x32x16_bf16 v[64:79], v[60:63], v[52:55], v[64:79]
    v_mfma_f32_32x32x16_bf16 v[80:95], v[60:63], v[56:59], v[80:95]
    s_cmp_eq_u32 s42, 0
    s_cbranch_scc0 K1_EPI_K
    s_lshl_b32 s60, s60, 10
    v_lshlrev_b32 v142, 4, v0
    s_mov_b32 s61, 1052289595
    s_add_u32 s62, s60, 0
    s_add_u32 s63, s60, 65536
    s_add_u32 s64, s60, 2048
    s_add_u32 s65, s60, 67584
    s_nop 2
    s_mov_b32 s60, s61
    v_pk_mul_f32 v[64:65], v[64:65], s[60:61]
    v_pk_mul_f32 v[66:67], v[66:67], s[60:61]
    v_pk_mul_f32 v[68:69], v[68:69], s[60:61]
    v_pk_mul_f32 v[70:71], v[70:71], s[60:61]
    v_pk_mul_f32 v[72:73], v[72:73], s[60:61]
    v_pk_mul_f32 v[74:75], v[74:75], s[60:61]
    v_pk_mul_f32 v[76:77], v[76:77], s[60:61]
    v_pk_mul_f32 v[78:79], v[78:79], s[60:61]
    v_pk_mul_f32 v[80:81], v[80:81], s[60:61]
    v_pk_mul_f32 v[82:83], v[82:83], s[60:61]
    v_pk_mul_f32 v[84:85], v[84:85], s[60:61]
    v_pk_mul_f32 v[86:87], v[86:87], s[60:61]
    v_pk_mul_f32 v[88:89], v[88:89], s[60:61]
    v_pk_mul_f32 v[90:91], v[90:91], s[60:61]
    v_pk_mul_f32 v[92:93], v[92:93], s[60:61]
    v_pk_mul_f32 v[94:95], v[94:95], s[60:61]
    s_branch K1_PACK
K1_EPI_K:
    s_lshl_b32 s60, s60, 11
    v_and_b32 v1, 0x33, v0
    v_bfe_u32 v2, v0, 2, 1
    v_bfe_u32 v3, v0, 3, 1
    v_lshl_add_u32 v1, v2, 3, v1
    v_lshl_add_u32 v1, v3, 2, v1
    v_lshlrev_b32 v142, 4, v1
    s_add_u32 s62, s60, 2097152
    s_add_u32 s63, s60, 2228224
    s_add_u32 s64, s60, 2101248
    s_add_u32 s65, s60, 2232320
    s_branch K1_PACK
K1_LOOP_XW:
    s_barrier
    ds_read_b128 v[16:19], v96 offset:0
    ds_read_b64_tr_b16 v[24:25], v104 offset:16384
    ds_read_b64_tr_b16 v[26:27], v104 offset:17408
    ds_read_b128 v[20:23], v96 offset:8192
    ds_read_b128 v[28:31], v97 offset:0
    ds_read_b64_tr_b16 v[36:37], v104 offset:20480
    ds_read_b64_tr_b16 v[38:39], v104 offset:21504
    ds_read_b128 v[32:35], v97 offset:8192
    ds_read_b128 v[40:43], v98 offset:0
    ds_read_b64_tr_b16 v[48:49], v104 offset:24576
    ds_read_b64_tr_b16 v[50:51], v104 offset:25600
    ds_read_b128 v[44:47], v98 offset:8192
    s_waitcnt lgkmcnt(8)
    v_mfma_f32_32x32x16_bf16 v[64:79], v[16:19], v[24:27], 0
    v_mfma_f32_32x32x16_bf16 v[80:95], v[20:23], v[24:27], 0
    ds_read_b128 v[52:55], v99 offset:0
    ds_read_b64_tr_b16 v[60:61], v104 offset:28672
    ds_read_b64_tr_b16 v[62:63], v104 offset:29696
    ds_read_b128 v[56:59], v99 offset:8192
    s_waitcnt lgkmcnt(8)
    v_mfma_f32_32x32x16_bf16 v[64:79], v[28:31], v[36:39], v[64:79]
    v_mfma_f32_32x32x16_bf16 v[80:95], v[32:35], v[36:39], v[80:95]
    s_barrier
    ds_read_b128 v[16:19], v96 offset:32768
    ds_read_b64_tr_b16 v[24:25], v104 offset:49152
    ds_read_b64_tr_b16 v[26:27], v104 offset:50176
    ds_read_b128 v[20:23], v96 offset:40960
    s_waitcnt lgkmcnt(8)
    v_mfma_f32_32x32x16_bf16 v[64:79], v[40:43], v[48:51], v[64:79]
    v_mfma_f32_32x32x16_bf16 v[80:95], v[44:47], v[48:51], v[80:95]
    ds_read_b128 v[28:31], v97 offset:32768
    ds_read_b64_tr_b16 v[36:37], v104 offset:53248
    ds_read_b64_tr_b16 v[38:39], v104 offset:54272
    ds_read_b128 v[32:35], v97 offset:40960
    s_waitcnt lgkmcnt(8)
    v_mfma_f32_32x32x16_bf16 v[64:79], v[52:55], v[60:63], v[64:79]
    v_mfma_f32_32x32x16_bf16 v[80:95], v[56:59], v[60:63], v[80:95]
    ds_read_b128 v[40:43], v98 offset:32768
    ds_read_b64_tr_b16 v[48:49], v104 offset:57344
    ds_read_b64_tr_b16 v[50:51], v104 offset:58368
    ds_read_b128 v[44:47], v98 offset:40960
    s_waitcnt lgkmcnt(8)
    v_mfma_f32_32x32x16_bf16 v[64:79], v[16:19], v[24:27], v[64:79]
    v_mfma_f32_32x32x16_bf16 v[80:95], v[20:23], v[24:27], v[80:95]
    ds_read_b128 v[52:55], v99 offset:32768
    ds_read_b64_tr_b16 v[60:61], v104 offset:61440
    ds_read_b64_tr_b16 v[62:63], v104 offset:62464
    ds_read_b128 v[56:59], v99 offset:40960
    s_waitcnt lgkmcnt(8)
    v_mfma_f32_32x32x16_bf16 v[64:79], v[28:31], v[36:39], v[64:79]
    v_mfma_f32_32x32x16_bf16 v[80:95], v[32:35], v[36:39], v[80:95]
    s_barrier
    ds_read_b128 v[16:19], v100 offset:0
    ds_read_b64_tr_b16 v[24:25], v105 offset:16384
    ds_read_b64_tr_b16 v[26:27], v105 offset:17408
    ds_read_b128 v[20:23], v100 offset:8192
    s_waitcnt lgkmcnt(8)
    v_mfma_f32_32x32x16_bf16 v[64:79], v[40:43], v[48:51], v[64:79]
    v_mfma_f32_32x32x16_bf16 v[80:95], v[44:47], v[48:51], v[80:95]
    ds_read_b128 v[28:31], v101 offset:0
    ds_read_b64_tr_b16 v[36:37], v105 offset:20480
    ds_read_b64_tr_b16 v[38:39], v105 offset:21504
    ds_read_b128 v[32:35], v101 offset:8192
    s_waitcnt lgkmcnt(8)
    v_mfma_f32_32x32x16_bf16 v[64:79], v[52:55], v[60:63], v[64:79]
    v_mfma_f32_32x32x16_bf16 v[80:95], v[56:59], v[60:63], v[80:95]
    ds_read_b128 v[40:43], v102 offset:0
    ds_read_b64_tr_b16 v[48:49], v105 offset:24576
    ds_read_b64_tr_b16 v[50:51], v105 offset:25600
    ds_read_b128 v[44:47], v102 offset:8192
    s_waitcnt lgkmcnt(8)
    v_mfma_f32_32x32x16_bf16 v[64:79], v[16:19], v[24:27], v[64:79]
    v_mfma_f32_32x32x16_bf16 v[80:95], v[20:23], v[24:27], v[80:95]
    ds_read_b128 v[52:55], v103 offset:0
    ds_read_b64_tr_b16 v[60:61], v105 offset:28672
    ds_read_b64_tr_b16 v[62:63], v105 offset:29696
    ds_read_b128 v[56:59], v103 offset:8192
    s_waitcnt lgkmcnt(8)
    v_mfma_f32_32x32x16_bf16 v[64:79], v[28:31], v[36:39], v[64:79]
    v_mfma_f32_32x32x16_bf16 v[80:95], v[32:35], v[36:39], v[80:95]
    s_barrier
    ds_read_b128 v[16:19], v100 offset:32768
    ds_read_b64_tr_b16 v[24:25], v105 offset:49152
    ds_read_b64_tr_b16 v[26:27], v105 offset:50176
    ds_read_b128 v[20:23], v100 offset:40960
    s_waitcnt lgkmcnt(8)
    v_mfma_f32_32x32x16_bf16 v[64:79], v[40:43], v[48:51], v[64:79]
    v_mfma_f32_32x32x16_bf16 v[80:95], v[44:47], v[48:51], v[80:95]
    ds_read_b128 v[28:31], v101 offset:32768
    ds_read_b64_tr_b16 v[36:37], v105 offset:53248
    ds_read_b64_tr_b16 v[38:39], v105 offset:54272
    ds_read_b128 v[32:35], v101 offset:40960
    s_waitcnt lgkmcnt(8)
    v_mfma_f32_32x32x16_bf16 v[64:79], v[52:55], v[60:63], v[64:79]
    v_mfma_f32_32x32x16_bf16 v[80:95], v[56:59], v[60:63], v[80:95]
    ds_read_b128 v[40:43], v102 offset:32768
    ds_read_b64_tr_b16 v[48:49], v105 offset:57344
    ds_read_b64_tr_b16 v[50:51], v105 offset:58368
    ds_read_b128 v[44:47], v102 offset:40960
    s_waitcnt lgkmcnt(8)
    v_mfma_f32_32x32x16_bf16 v[64:79], v[16:19], v[24:27], v[64:79]
    v_mfma_f32_32x32x16_bf16 v[80:95], v[20:23], v[24:27], v[80:95]
    ds_read_b128 v[52:55], v103 offset:32768
    ds_read_b64_tr_b16 v[60:61], v105 offset:61440
    ds_read_b64_tr_b16 v[62:63], v105 offset:62464
    ds_read_b128 v[56:59], v103 offset:40960
    s_waitcnt lgkmcnt(8)
    v_mfma_f32_32x32x16_bf16 v[64:79], v[28:31], v[36:39], v[64:79]
    v_mfma_f32_32x32x16_bf16 v[80:95], v[32:35], v[36:39], v[80:95]
    s_barrier
    ds_read_b128 v[16:19], v96 offset:0
    ds_read_b64_tr_b16 v[24:25], v104 offset:16384
    ds_read_b64_tr_b16 v[26:27], v104 offset:17408
    ds_read_b128 v[20:23], v96 offset:8192
    s_waitcnt lgkmcnt(8)
    v_mfma_f32_32x32x16_bf16 v[64:79], v[40:43], v[48:51], v[64:79]
    v_mfma_f32_32x32x16_bf16 v[80:95], v[44:47], v[48:51], v[80:95]
    ds_read_b128 v[28:31], v97 offset:0
    ds_read_b64_tr_b16 v[36:37], v104 offset:20480
    ds_read_b64_tr_b16 v[38:39], v104 offset:21504
    ds_read_b128 v[32:35], v97 offset:8192
    s_waitcnt lgkmcnt(8)
    v_mfma_f32_32x32x16_bf16 v[64:79], v[52:55], v[60:63], v[64:79]
    v_mfma_f32_32x32x16_bf16 v[80:95], v[56:59], v[60:63], v[80:95]
    ds_read_b128 v[40:43], v98 offset:0
    ds_read_b64_tr_b16 v[48:49], v104 offset:24576
    ds_read_b64_tr_b16 v[50:51], v104 offset:25600
    ds_read_b128 v[44:47], v98 offset:8192
    s_waitcnt lgkmcnt(8)
    v_mfma_f32_32x32x16_bf16 v[64:79], v[16:19], v[24:27], v[64:79]
    v_mfma_f32_32x32x16_bf16 v[80:95], v[20:23], v[24:27], v[80:95]
    ds_read_b128 v[52:55], v99 offset:0
    ds_read_b64_tr_b16 v[60:61], v104 offset:28672
    ds_read_b64_tr_b16 v[62:63], v104 offset:29696
    ds_read_b128 v[56:59], v99 offset:8192
    s_waitcnt lgkmcnt(8)
    v_mfma_f32_32x32x16_bf16 v[64:79], v[28:31], v[36:39], v[64:79]
    v_mfma_f32_32x32x16_bf16 v[80:95], v[32:35], v[36:39], v[80:95]
    s_barrier
    ds_read_b128 v[16:19], v96 offset:32768
    ds_read_b64_tr_b16 v[24:25], v104 offset:49152
    ds_read_b64_tr_b16 v[26:27], v104 offset:50176
    ds_read_b128 v[20:23], v96 offset:40960
    s_waitcnt lgkmcnt(8)
    v_mfma_f32_32x32x16_bf16 v[64:79], v[40:43], v[48:51], v[64:79]
    v_mfma_f32_32x32x16_bf16 v[80:95], v[44:47], v[48:51], v[80:95]
    ds_read_b128 v[28:31], v97 offset:32768
    ds_read_b64_tr_b16 v[36:37], v104 offset:53248
    ds_read_b64_tr_b16 v[38:39], v104 offset:54272
    ds_read_b128 v[32:35], v97 offset:40960
    s_waitcnt lgkmcnt(8)
    v_mfma_f32_32x32x16_bf16 v[64:79], v[52:55], v[60:63], v[64:79]
    v_mfma_f32_32x32x16_bf16 v[80:95], v[56:59], v[60:63], v[80:95]
    ds_read_b128 v[40:43], v98 offset:32768
    ds_read_b64_tr_b16 v[48:49], v104 offset:57344
    ds_read_b64_tr_b16 v[50:51], v104 offset:58368
    ds_read_b128 v[44:47], v98 offset:40960
    s_waitcnt lgkmcnt(8)
    v_mfma_f32_32x32x16_bf16 v[64:79], v[16:19], v[24:27], v[64:79]
    v_mfma_f32_32x32x16_bf16 v[80:95], v[20:23], v[24:27], v[80:95]
    ds_read_b128 v[52:55], v99 offset:32768
    ds_read_b64_tr_b16 v[60:61], v104 offset:61440
    ds_read_b64_tr_b16 v[62:63], v104 offset:62464
    ds_read_b128 v[56:59], v99 offset:40960
    s_waitcnt lgkmcnt(8)
    v_mfma_f32_32x32x16_bf16 v[64:79], v[28:31], v[36:39], v[64:79]
    v_mfma_f32_32x32x16_bf16 v[80:95], v[32:35], v[36:39], v[80:95]
    s_barrier
    ds_read_b128 v[16:19], v100 offset:0
    ds_read_b64_tr_b16 v[24:25], v105 offset:16384
    ds_read_b64_tr_b16 v[26:27], v105 offset:17408
    ds_read_b128 v[20:23], v100 offset:8192
    s_waitcnt lgkmcnt(8)
    v_mfma_f32_32x32x16_bf16 v[64:79], v[40:43], v[48:51], v[64:79]
    v_mfma_f32_32x32x16_bf16 v[80:95], v[44:47], v[48:51], v[80:95]
    ds_read_b128 v[28:31], v101 offset:0
    ds_read_b64_tr_b16 v[36:37], v105 offset:20480
    ds_read_b64_tr_b16 v[38:39], v105 offset:21504
    ds_read_b128 v[32:35], v101 offset:8192
    s_waitcnt lgkmcnt(8)
    v_mfma_f32_32x32x16_bf16 v[64:79], v[52:55], v[60:63], v[64:79]
    v_mfma_f32_32x32x16_bf16 v[80:95], v[56:59], v[60:63], v[80:95]
    ds_read_b128 v[40:43], v102 offset:0
    ds_read_b64_tr_b16 v[48:49], v105 offset:24576
    ds_read_b64_tr_b16 v[50:51], v105 offset:25600
    ds_read_b128 v[44:47], v102 offset:8192
    s_waitcnt lgkmcnt(8)
    v_mfma_f32_32x32x16_bf16 v[64:79], v[16:19], v[24:27], v[64:79]
    v_mfma_f32_32x32x16_bf16 v[80:95], v[20:23], v[24:27], v[80:95]
    ds_read_b128 v[52:55], v103 offset:0
    ds_read_b64_tr_b16 v[60:61], v105 offset:28672
    ds_read_b64_tr_b16 v[62:63], v105 offset:29696
    ds_read_b128 v[56:59], v103 offset:8192
    s_waitcnt lgkmcnt(8)
    v_mfma_f32_32x32x16_bf16 v[64:79], v[28:31], v[36:39], v[64:79]
    v_mfma_f32_32x32x16_bf16 v[80:95], v[32:35], v[36:39], v[80:95]
    s_barrier
    ds_read_b128 v[16:19], v100 offset:32768
    ds_read_b64_tr_b16 v[24:25], v105 offset:49152
    ds_read_b64_tr_b16 v[26:27], v105 offset:50176
    ds_read_b128 v[20:23], v100 offset:40960
    s_waitcnt lgkmcnt(8)
    v_mfma_f32_32x32x16_bf16 v[64:79], v[40:43], v[48:51], v[64:79]
    v_mfma_f32_32x32x16_bf16 v[80:95], v[44:47], v[48:51], v[80:95]
    ds_read_b128 v[28:31], v101 offset:32768
    ds_read_b64_tr_b16 v[36:37], v105 offset:53248
    ds_read_b64_tr_b16 v[38:39], v105 offset:54272
    ds_read_b128 v[32:35], v101 offset:40960
    s_waitcnt lgkmcnt(8)
    v_mfma_f32_32x32x16_bf16 v[64:79], v[52:55], v[60:63], v[64:79]
    v_mfma_f32_32x32x16_bf16 v[80:95], v[56:59], v[60:63], v[80:95]
    ds_read_b128 v[40:43], v102 offset:32768
    ds_read_b64_tr_b16 v[48:49], v105 offset:57344
    ds_read_b64_tr_b16 v[50:51], v105 offset:58368
    ds_read_b128 v[44:47], v102 offset:40960
    s_waitcnt lgkmcnt(8)
    v_mfma_f32_32x32x16_bf16 v[64:79], v[16:19], v[24:27], v[64:79]
    v_mfma_f32_32x32x16_bf16 v[80:95], v[20:23], v[24:27], v[80:95]
    ds_read_b128 v[52:55], v103 offset:32768
    ds_read_b64_tr_b16 v[60:61], v105 offset:61440
    ds_read_b64_tr_b16 v[62:63], v105 offset:62464
    ds_read_b128 v[56:59], v103 offset:40960
    s_waitcnt lgkmcnt(8)
    v_mfma_f32_32x32x16_bf16 v[64:79], v[28:31], v[36:39], v[64:79]
    v_mfma_f32_32x32x16_bf16 v[80:95], v[32:35], v[36:39], v[80:95]
    s_waitcnt lgkmcnt(4)
    v_mfma_f32_32x32x16_bf16 v[64:79], v[40:43], v[48:51], v[64:79]
    v_mfma_f32_32x32x16_bf16 v[80:95], v[44:47], v[48:51], v[80:95]
    s_waitcnt lgkmcnt(0)
    v_mfma_f32_32x32x16_bf16 v[64:79], v[52:55], v[60:63], v[64:79]
    v_mfma_f32_32x32x16_bf16 v[80:95], v[56:59], v[60:63], v[80:95]
    s_lshl_b32 s60, s60, 11
    v_and_b32 v1, 15, v0
    v_lshlrev_b32 v1, 4, v1
    v_bfe_u32 v2, v0, 4, 1
    v_lshl_add_u32 v1, v2, 17, v1
    v_lshl_add_u32 v142, v7, 8, v1
    s_add_u32 s62, s60, 2098176
    s_add_u32 s63, s60, 2098688
    s_add_u32 s64, s60, 2102272
    s_add_u32 s65, s60, 2102784
    s_nop 1
K1_PACK:
    v_cvt_pk_bf16_f32 v144, v64, v65
    v_cvt_pk_bf16_f32 v145, v66, v67
    v_cvt_pk_bf16_f32 v146, v68, v69
    v_cvt_pk_bf16_f32 v147, v70, v71
    v_cvt_pk_bf16_f32 v148, v72, v73
    v_cvt_pk_bf16_f32 v149, v74, v75
    v_cvt_pk_bf16_f32 v150, v76, v77
    v_cvt_pk_bf16_f32 v151, v78, v79
    v_cvt_pk_bf16_f32 v152, v80, v81
    v_cvt_pk_bf16_f32 v153, v82, v83
    v_cvt_pk_bf16_f32 v154, v84, v85
    v_cvt_pk_bf16_f32 v155, v86, v87
    v_cvt_pk_bf16_f32 v156, v88, v89
    v_cvt_pk_bf16_f32 v157, v90, v91
    v_cvt_pk_bf16_f32 v158, v92, v93
    v_cvt_pk_bf16_f32 v159, v94, v95
    s_cmp_lg_u32 s66, 0
    s_cbranch_scc1 K1_DONE
    buffer_store_dwordx4 v[144:147], v142, s[28:31], s62 offen sc1
    buffer_store_dwordx4 v[148:151], v142, s[28:31], s63 offen sc1
    buffer_store_dwordx4 v[152:155], v142, s[28:31], s64 offen sc1
    buffer_store_dwordx4 v[156:159], v142, s[28:31], s65 offen sc1
K1_DONE:
    s_and_b32 s40, s2, 7
    s_lshr_b32 s41, s2, 3
    s_lshl_b32 s40, s40, 2
    s_lshr_b32 s45, s41, 3
    s_add_u32 s40, s40, s45
    s_and_b32 s41, s41, 7
    s_and_b32 s33, s26, 3
    s_lshr_b32 s34, s26, 2
    s_lshl_b32 s35, s41, 3
    s_lshl_b32 s36, s33, 1
    s_add_u32 s35, s35, s36
    v_lshlrev_b32 v36, 4, v0
    v_and_b32 v39, 15, v0
    v_lshrrev_b32 v38, 5, v0
    v_lshlrev_b32 v39, 4, v39
    v_lshl_add_u32 v39, v38, 8, v39
    v_bfe_u32 v38, v0, 4, 1
    v_lshl_add_u32 v39, v38, 18, v39
    v_and_b32 v41, 27, v0
    v_cmp_eq_u32 vcc, 16, v41
    v_add_u32 v16, 1024, v39
    v_add_u32 v17, 1536, v39
    v_mov_b32 v41, 2048
    v_mov_b32 v3, 0xdddddddd
    v_cndmask_b32 v16, v16, v41, vcc
    v_cndmask_b32 v17, v17, v41, vcc
    s_mov_b32 s42, 0
    s_mov_b32 s32, 0xffff0003
    s_lshl_b32 s36, s33, 11
    s_add_u32 s36, s36, 132352
    v_add_u32 v41, s36, v36
    v_mov_b32 v46, 132096
    s_lshl_b32 s36, s33, 2
    s_add_u32 s36, s36, 132128
    v_mov_b32 v18, s36
    v_mov_b32 v19, 1
    v_mov_b64 v[80:81], 0
    v_mov_b64 v[82:83], 0
    v_mov_b64 v[84:85], 0
    v_mov_b64 v[86:87], 0
    v_mov_b64 v[88:89], 0
    v_mov_b64 v[90:91], 0
    v_mov_b64 v[92:93], 0
    v_mov_b64 v[94:95], 0
    v_mov_b64 v[96:97], 0
    v_mov_b64 v[98:99], 0
    v_mov_b64 v[100:101], 0
    v_mov_b64 v[102:103], 0
    v_mov_b64 v[104:105], 0
    v_mov_b64 v[106:107], 0
    v_mov_b64 v[108:109], 0
    v_mov_b64 v[110:111], 0
    v_mov_b64 v[32:33], 0
    v_mov_b64 v[34:35], 0
    s_waitcnt vmcnt(0)
    s_barrier
    s_barrier
    ds_read_b128 v[4:7], v41
    ds_read_b128 v[8:11], v41 offset:1024
    ds_read_b128 v[12:15], v36
    ds_read_b32 v44, v46 offset:16
    s_cmp_eq_u32 s66, 0
    s_cbranch_scc1 K2_NODEF
    buffer_store_dwordx4 v[144:147], v142, s[28:31], s62 offen sc1
    buffer_store_dwordx4 v[148:151], v142, s[28:31], s63 offen sc1
    buffer_store_dwordx4 v[152:155], v142, s[28:31], s64 offen sc1
    buffer_store_dwordx4 v[156:159], v142, s[28:31], s65 offen sc1
K2_NODEF:
    s_waitcnt lgkmcnt(0)
    v_mfma_f32_32x32x16_bf16 v[48:63], v[12:15], v[4:7], 0
    v_mfma_f32_32x32x16_bf16 v[64:79], v[12:15], v[8:11], 0
    v_readfirstlane_b32 s27, v44
    s_cmp_lg_u32 s34, 0
    s_cbranch_scc1 K2_FILL
    s_setprio 1
    s_nop 6
    s_branch K2_GO
K2_FILL:
    s_nop 7
    s_cmp_eq_u32 s66, 0
    s_cbranch_scc1 K2_GO
    s_waitcnt vmcnt(0)
    s_mov_b64 exec, 1
    ds_add_rtn_u32 v44, v46, v19 offset:20
    v_mov_b32 v45, s27
    v_mov_b32 v43, 0
    s_waitcnt lgkmcnt(0)
    v_cmp_eq_u32 vcc, 7, v44
    s_mov_b32 s66, 0
    s_cbranch_vccz K2_AD0
    buffer_store_dword v45, v43, s[28:31], s67 offen sc1
K2_AD0:
    s_mov_b64 exec, -1
K2_GO:
    v_max3_f32 v41, v48, v49, v50
    v_max3_f32 v41, v41, v51, v52
    v_max3_f32 v41, v41, v53, v54
    v_max3_f32 v41, v41, v55, v56
    v_max3_f32 v41, v41, v57, v58
    v_max3_f32 v41, v41, v59, v60
    v_max3_f32 v41, v41, v61, v62
    v_max_f32 v41, v41, v63
    v_max3_f32 v42, v64, v65, v66
    v_max3_f32 v42, v42, v67, v68
    v_max3_f32 v42, v42, v69, v70
    v_max3_f32 v42, v42, v71, v72
    v_max3_f32 v42, v42, v73, v74
    v_max3_f32 v42, v42, v75, v76
    v_max3_f32 v42, v42, v77, v78
    v_max_f32 v42, v42, v79
    v_mov_b32 v43, v41
    s_nop 1
    v_permlane32_swap_b32 v41, v43
    s_nop 1
    v_max_f32 v41, v41, v43
    v_mov_b32 v44, v42
    s_nop 1
    v_permlane32_swap_b32 v42, v44
    s_nop 1
    v_max_f32 v42, v42, v44
    v_mov_b32 v43, 3267887104
    v_sub_f32 v41, v43, v41
    v_sub_f32 v42, v43, v42
K2_RESTART:
    s_mul_i32 s44, s34, 8256
    v_add_u32 v1, s44, v36
    v_add_u32 v2, s44, v16
    v_add_u32 v47, s44, v17
    ds_read_b128 v[12:15], v1
    ds_read_b128 v[20:23], v2
    ds_read_b128 v[24:27], v47
    v_mov_b32 v40, v41
    v_mov_b32 v43, v42
    v_mov_b64 v[112:113], v[40:41]
    v_mov_b64 v[114:115], v[40:41]
    v_mov_b64 v[116:117], v[40:41]
    v_mov_b64 v[118:119], v[40:41]
    v_mov_b64 v[120:121], v[40:41]
    v_mov_b64 v[122:123], v[40:41]
    v_mov_b64 v[124:125], v[40:41]
    v_mov_b64 v[126:127], v[40:41]
    v_mov_b64 v[128:129], v[42:43]
    v_mov_b64 v[130:131], v[42:43]
    v_mov_b64 v[132:133], v[42:43]
    v_mov_b64 v[134:135], v[42:43]
    v_mov_b64 v[136:137], v[42:43]
    v_mov_b64 v[138:139], v[42:43]
    v_mov_b64 v[140:141], v[42:43]
    v_mov_b64 v[142:143], v[42:43]
    v_mov_b64 v[72:73], 0
    v_mov_b64 v[74:75], 0
    v_mov_b64 v[76:77], 0
    v_mov_b64 v[78:79], 0
    s_waitcnt lgkmcnt(0)
    v_mfma_f32_32x32x16_bf16 v[48:63], v[12:15], v[4:7], v[112:127]
    s_nop 10
    s_branch K2_LOOP
K2_SPIN:
K2_SPIN2:
    ds_read_b64 v[44:45], v46
    s_waitcnt lgkmcnt(0)
    v_and_b32 v44, v44, v45
    s_nop 0
    v_readfirstlane_b32 s32, v44
    s_or_b32 s32, s32, 0xffff0000
    s_bitcmp1_b32 s32, s43
    s_cbranch_scc0 K2_SPIN2
    s_branch K2_READY
K2_BACK:
    s_cmp_eq_u32 s66, 0
    s_cbranch_scc1 K2_LOOP
    s_waitcnt vmcnt(0)
    s_mov_b64 exec, 1
    ds_add_rtn_u32 v44, v46, v19 offset:20
    v_mov_b32 v45, s27
    v_mov_b32 v43, 0
    s_waitcnt lgkmcnt(0)
    v_cmp_eq_u32 vcc, 7, v44
    s_mov_b32 s66, 0
    s_cbranch_vccz K2_AD1
    buffer_store_dword v45, v43, s[28:31], s67 offen sc1
K2_AD1:
    s_mov_b64 exec, -1
K2_LOOP:
    v_exp_f32 v48, v48
    v_exp_f32 v49, v49
    v_smfmac_f32_32x32x32_bf16 v[96:111], v[32:35], v[72:79], v3
    v_exp_f32 v50, v50
    v_exp_f32 v51, v51
    v_exp_f32 v52, v52
    v_mfma_f32_32x32x16_bf16 v[64:79], v[12:15], v[8:11], v[128:143]
    ds_read_b128 v[12:15], v1 offset:2064
    ds_read_b128 v[28:31], v2 offset:2064
    ds_read_b128 v[32:35], v47 offset:2064
    v_exp_f32 v53, v53
    v_exp_f32 v54, v54
    v_exp_f32 v55, v55
    v_exp_f32 v56, v56
    v_exp_f32 v57, v57
    v_smfmac_f32_32x32x32_bf16 v[80:95], v[20:23], v[48:55], v3
    v_exp_f32 v58, v58
    v_exp_f32 v59, v59
    v_exp_f32 v60, v60
    v_exp_f32 v61, v61
    v_exp_f32 v62, v62
    v_exp_f32 v63, v63
    v_exp_f32 v64, v64
    v_exp_f32 v65, v65
    v_smfmac_f32_32x32x32_bf16 v[80:95], v[24:27], v[56:63], v3
    v_exp_f32 v66, v66
    v_exp_f32 v67, v67
    v_exp_f32 v68, v68
    s_waitcnt lgkmcnt(0)
    v_mfma_f32_32x32x16_bf16 v[48:63], v[12:15], v[4:7], v[112:127]
    v_exp_f32 v69, v69
    v_exp_f32 v70, v70
    v_exp_f32 v71, v71
    v_exp_f32 v72, v72
    v_exp_f32 v73, v73
    v_smfmac_f32_32x32x32_bf16 v[96:111], v[20:23], v[64:71], v3
    v_exp_f32 v74, v74
    v_exp_f32 v75, v75
    v_exp_f32 v76, v76
    v_exp_f32 v77, v77
    v_exp_f32 v78, v78
    v_exp_f32 v79, v79
    v_exp_f32 v48, v48
    v_exp_f32 v49, v49
    v_smfmac_f32_32x32x32_bf16 v[96:111], v[24:27], v[72:79], v3
    v_exp_f32 v50, v50
    v_exp_f32 v51, v51
    v_exp_f32 v52, v52
    v_mfma_f32_32x32x16_bf16 v[64:79], v[12:15], v[8:11], v[128:143]
    ds_read_b128 v[12:15], v1 offset:4128
    ds_read_b128 v[20:23], v2 offset:4128
    ds_read_b128 v[24:27], v47 offset:4128
    v_exp_f32 v53, v53
    v_exp_f32 v54, v54
    v_exp_f32 v55, v55
    v_exp_f32 v56, v56
    v_exp_f32 v57, v57
    v_smfmac_f32_32x32x32_bf16 v[80:95], v[28:31], v[48:55], v3
    v_exp_f32 v58, v58
    v_exp_f32 v59, v59
    v_exp_f32 v60, v60
    v_exp_f32 v61, v61
    v_exp_f32 v62, v62
    v_exp_f32 v63, v63
    v_exp_f32 v64, v64
    v_exp_f32 v65, v65
    v_smfmac_f32_32x32x32_bf16 v[80:95], v[32:35], v[56:63], v3
    v_exp_f32 v66, v66
    v_exp_f32 v67, v67
    v_exp_f32 v68, v68
    s_waitcnt lgkmcnt(0)
    v_mfma_f32_32x32x16_bf16 v[48:63], v[12:15], v[4:7], v[112:127]
    v_exp_f32 v69, v69
    v_exp_f32 v70, v70
    v_exp_f32 v71, v71
    v_exp_f32 v72, v72
    v_exp_f32 v73, v73
    v_smfmac_f32_32x32x32_bf16 v[96:111], v[28:31], v[64:71], v3
    v_exp_f32 v74, v74
    v_exp_f32 v75, v75
    v_exp_f32 v76, v76
    v_exp_f32 v77, v77
    v_exp_f32 v78, v78
    v_exp_f32 v79, v79
    v_exp_f32 v48, v48
    v_exp_f32 v49, v49
    v_smfmac_f32_32x32x32_bf16 v[96:111], v[32:35], v[72:79], v3
    v_exp_f32 v50, v50
    v_exp_f32 v51, v51
    v_exp_f32 v52, v52
    v_mfma_f32_32x32x16_bf16 v[64:79], v[12:15], v[8:11], v[128:143]
    ds_read_b128 v[12:15], v1 offset:6192
    ds_read_b128 v[28:31], v2 offset:6192
    ds_read_b128 v[32:35], v47 offset:6192
    s_mov_b64 exec, 1
    ds_add_rtn_u32 v43, v18, v19
    s_mov_b64 exec, -1
    v_exp_f32 v53, v53
    v_exp_f32 v54, v54
    v_exp_f32 v55, v55
    v_exp_f32 v56, v56
    v_exp_f32 v57, v57
    v_smfmac_f32_32x32x32_bf16 v[80:95], v[20:23], v[48:55], v3
    v_exp_f32 v58, v58
    v_exp_f32 v59, v59
    v_exp_f32 v60, v60
    v_exp_f32 v61, v61
    v_exp_f32 v62, v62
    v_exp_f32 v63, v63
    v_exp_f32 v64, v64
    v_exp_f32 v65, v65
    v_smfmac_f32_32x32x32_bf16 v[80:95], v[24:27], v[56:63], v3
    v_exp_f32 v66, v66
    v_exp_f32 v67, v67
    v_exp_f32 v68, v68
    s_waitcnt lgkmcnt(0)
    v_mfma_f32_32x32x16_bf16 v[48:63], v[12:15], v[4:7], v[112:127]
    v_exp_f32 v69, v69
    v_exp_f32 v70, v70
    v_exp_f32 v71, v71
    v_exp_f32 v72, v72
    v_exp_f32 v73, v73
    v_smfmac_f32_32x32x32_bf16 v[96:111], v[20:23], v[64:71], v3
    v_readfirstlane_b32 s43, v43
    v_exp_f32 v74, v74
    v_exp_f32 v75, v75
    v_exp_f32 v76, v76
    v_exp_f32 v77, v77
    v_exp_f32 v78, v78
    v_exp_f32 v79, v79
    v_exp_f32 v48, v48
    v_exp_f32 v49, v49
    v_smfmac_f32_32x32x32_bf16 v[96:111], v[24:27], v[72:79], v3
    v_exp_f32 v50, v50
    v_exp_f32 v51, v51
    v_exp_f32 v52, v52
    v_mfma_f32_32x32x16_bf16 v[64:79], v[12:15], v[8:11], v[128:143]
    s_min_u32 s44, s43, 15
    s_mulk_i32 s44, 8256
    s_bitcmp1_b32 s32, s43
    s_cbranch_scc0 K2_SPIN
K2_READY:
    v_add_u32 v1, s44, v36
    v_add_u32 v2, s44, v16
    v_add_u32 v47, s44, v17
    ds_read_b128 v[12:15], v1 offset:0
    ds_read_b128 v[20:23], v2 offset:0
    ds_read_b128 v[24:27], v47 offset:0
    v_exp_f32 v53, v53
    v_exp_f32 v54, v54
    v_exp_f32 v55, v55
    v_exp_f32 v56, v56
    v_exp_f32 v57, v57
    v_smfmac_f32_32x32x32_bf16 v[80:95], v[28:31], v[48:55], v3
    v_exp_f32 v58, v58
    v_exp_f32 v59, v59
    v_exp_f32 v60, v60
    v_exp_f32 v61, v61
    v_exp_f32 v62, v62
    v_exp_f32 v63, v63
    v_exp_f32 v64, v64
    v_exp_f32 v65, v65
    v_smfmac_f32_32x32x32_bf16 v[80:95], v[32:35], v[56:63], v3
    v_exp_f32 v66, v66
    v_exp_f32 v67, v67
    v_exp_f32 v68, v68
    s_waitcnt lgkmcnt(0)
    v_mfma_f32_32x32x16_bf16 v[48:63], v[12:15], v[4:7], v[112:127]
    v_exp_f32 v69, v69
    v_exp_f32 v70, v70
    v_exp_f32 v71, v71
    v_exp_f32 v72, v72
    v_exp_f32 v73, v73
    v_smfmac_f32_32x32x32_bf16 v[96:111], v[28:31], v[64:71], v3
    s_cmp_lt_u32 s43, 16
    v_exp_f32 v74, v74
    v_exp_f32 v75, v75
    v_exp_f32 v76, v76
    v_exp_f32 v77, v77
    v_exp_f32 v78, v78
    v_exp_f32 v79, v79
    s_cbranch_scc1 K2_BACK
    s_nop 1
    v_smfmac_f32_32x32x32_bf16 v[96:111], v[32:35], v[72:79], v3
    s_setprio 0
    s_cmp_eq_u32 s66, 0
    s_cbranch_scc1 K2_NOAD
    s_waitcnt vmcnt(0)
    s_mov_b64 exec, 1
    ds_add_rtn_u32 v44, v46, v19 offset:20
    v_mov_b32 v45, s27
    v_mov_b32 v43, 0
    s_waitcnt lgkmcnt(0)
    v_cmp_eq_u32 vcc, 7, v44
    s_mov_b32 s66, 0
    s_cbranch_vccz K2_AD2
    buffer_store_dword v45, v43, s[28:31], s67 offen sc1
K2_AD2:
    s_mov_b64 exec, -1
K2_NOAD:
    s_nop 1
    s_mul_i32 s44, s26, 2304
    s_add_u32 s44, s44, 132352
    v_add_u32 v45, s44, v36
    v_lshlrev_b32 v46, 2, v0
    v_add_u32 v46, s44, v46
    s_mov_b32 s44, 1904214016
    s_mov_b32 s45, 0x7f800000
    s_mov_b32 s46, 218103808
    s_mov_b32 s47, 184549376
    s_cmp_lg_u32 s42, 0
    s_cbranch_scc1 K2_GOOD
    v_add_f32 v43, abs(v80), abs(v81)
    v_add_f32 v43, v43, abs(v82)
    v_add_f32 v43, v43, abs(v83)
    v_add_f32 v43, v43, abs(v84)
    v_add_f32 v43, v43, abs(v85)
    v_add_f32 v43, v43, abs(v86)
    v_add_f32 v43, v43, abs(v87)
    v_cmp_ngt_f32 s[48:49], s44, v88
    v_cmp_ngt_f32 s[50:51], s45, v43
    v_cmp_le_f32 s[52:53], s46, v88
    v_cmp_gt_f32 vcc, s47, v43
    s_or_b64 s[48:49], s[48:49], s[50:51]
    s_and_b64 vcc, vcc, s[52:53]
    s_or_b64 s[54:55], s[48:49], vcc
    v_add_f32 v44, abs(v96), abs(v97)
    v_add_f32 v44, v44, abs(v98)
    v_add_f32 v44, v44, abs(v99)
    v_add_f32 v44, v44, abs(v100)
    v_add_f32 v44, v44, abs(v101)
    v_add_f32 v44, v44, abs(v102)
    v_add_f32 v44, v44, abs(v103)
    v_cmp_ngt_f32 s[48:49], s44, v104
    v_cmp_ngt_f32 s[50:51], s45, v44
    v_cmp_le_f32 s[52:53], s46, v104
    v_cmp_gt_f32 vcc, s47, v44
    s_or_b64 s[48:49], s[48:49], s[50:51]
    s_and_b64 vcc, vcc, s[52:53]
    s_or_b64 s[56:57], s[48:49], vcc
    s_or_b64 s[54:55], s[54:55], s[56:57]
    s_cbranch_scc0 K2_GOOD
    v_mov_b32 v43, 132104
    v_mov_b32 v44, 1
    ds_write_b32 v43, v44
K2_GOOD:
    s_cmp_eq_u32 s34, 0
    s_cbranch_scc1 K2_SENDB
    ds_write_b128 v45, v[80:83]
    ds_write_b128 v45, v[84:87] offset:1024
    ds_write_b32 v46, v88 offset:2048
    s_waitcnt lgkmcnt(0)
    v_mov_b32 v80, v96
    v_mov_b32 v81, v97
    v_mov_b32 v82, v98
    v_mov_b32 v83, v99
    v_mov_b32 v84, v100
    v_mov_b32 v85, v101
    v_mov_b32 v86, v102
    v_mov_b32 v87, v103
    v_mov_b32 v88, v104
    v_subrev_u32 v45, 9216, v45
    v_subrev_u32 v46, 9216, v46
    s_branch K2_SENT
K2_SENDB:
    ds_write_b128 v45, v[96:99]
    ds_write_b128 v45, v[100:103] offset:1024
    ds_write_b32 v46, v104 offset:2048
    v_add_u32 v45, 9216, v45
    v_add_u32 v46, 9216, v46
K2_SENT:
    v_mov_b32 v43, 132104
    s_waitcnt lgkmcnt(0)
    s_barrier
    ds_read_b32 v44, v43
    ds_read_b128 v[48:51], v45
    ds_read_b128 v[52:55], v45 offset:1024
    ds_read_b32 v56, v46 offset:2048
    s_add_u32 s36, s35, s34
    s_lshl_b32 s36, s36, 5
    s_add_u32 s36, s36, s40
    s_lshl_b32 s36, s36, 10
    s_add_u32 s36, s36, 8388608
    s_waitcnt lgkmcnt(3)
    v_readfirstlane_b32 s44, v44
    s_cmp_lt_u32 s42, s44
    s_cbranch_scc0 K2_COMBINE
    s_mov_b32 s42, 1
    v_mov_b32 v41, 0xff800000
    v_mov_b32 v42, 0xff800000
    s_mul_i32 s44, s34, 66048
    v_add_u32 v45, s44, v36
    v_mov_b32 v43, 2
    ds_write_b32 v18, v43
    s_mov_b32 s43, 32
K2_MAXLOOP:
    ds_read_b128 v[12:15], v45
    v_add_u32 v45, 2064, v45
    s_waitcnt lgkmcnt(0)
    v_mfma_f32_32x32x16_bf16 v[48:63], v[12:15], v[4:7], 0
    v_mfma_f32_32x32x16_bf16 v[64:79], v[12:15], v[8:11], 0
    s_nop 11
    v_max3_f32 v41, v41, v48, v49
    v_max3_f32 v41, v41, v50, v51
    v_max3_f32 v41, v41, v52, v53
    v_max3_f32 v41, v41, v54, v55
    v_max3_f32 v41, v41, v56, v57
    v_max3_f32 v41, v41, v58, v59
    v_max3_f32 v41, v41, v60, v61
    v_max3_f32 v41, v41, v62, v63
    v_max3_f32 v42, v42, v64, v65
    v_max3_f32 v42, v42, v66, v67
    v_max3_f32 v42, v42, v68, v69
    v_max3_f32 v42, v42, v70, v71
    v_max3_f32 v42, v42, v72, v73
    v_max3_f32 v42, v42, v74, v75
    v_max3_f32 v42, v42, v76, v77
    v_max3_f32 v42, v42, v78, v79
    s_sub_u32 s43, s43, 1
    s_cmp_lg_u32 s43, 0
    s_cbranch_scc1 K2_MAXLOOP
    v_mov_b32 v43, v41
    s_nop 1
    v_permlane32_swap_b32 v41, v43
    s_nop 1
    v_max_f32 v41, v41, v43
    v_mov_b32 v44, v42
    s_nop 1
    v_permlane32_swap_b32 v42, v44
    s_nop 1
    v_max_f32 v42, v42, v44
    s_lshl_b32 s44, s26, 9
    v_lshlrev_b32 v43, 2, v0
    v_add_u32 v43, s44, v43
    v_xor_b32 v45, 0x800, v43
    v_add_u32 v43, 150784, v43
    v_add_u32 v45, 150784, v45
    ds_write_b32 v43, v41
    ds_write_b32 v43, v42 offset:256
    s_waitcnt lgkmcnt(0)
    s_barrier
    ds_read_b32 v44, v45
    ds_read_b32 v45, v45 offset:256
    s_waitcnt lgkmcnt(0)
    v_max_f32 v41, v41, v44
    v_max_f32 v42, v42, v45
    v_sub_f32 v41, 0, v41
    v_sub_f32 v42, 0, v42
    v_mov_b32 v46, 132096
    v_mov_b64 v[80:81], 0
    v_mov_b64 v[82:83], 0
    v_mov_b64 v[84:85], 0
    v_mov_b64 v[86:87], 0
    v_mov_b64 v[88:89], 0
    v_mov_b64 v[90:91], 0
    v_mov_b64 v[92:93], 0
    v_mov_b64 v[94:95], 0
    v_mov_b64 v[96:97], 0
    v_mov_b64 v[98:99], 0
    v_mov_b64 v[100:101], 0
    v_mov_b64 v[102:103], 0
    v_mov_b64 v[104:105], 0
    v_mov_b64 v[106:107], 0
    v_mov_b64 v[108:109], 0
    v_mov_b64 v[110:111], 0
    v_mov_b64 v[32:33], 0
    v_mov_b64 v[34:35], 0
    s_branch K2_RESTART
K2_COMBINE:
    s_and_b32 s44, s40, 7
    s_waitcnt lgkmcnt(0)
    v_add_f32 v88, v88, v56
    v_rcp_f32 v88, v88
    v_add_f32 v80, v80, v48
    v_add_f32 v81, v81, v49
    v_add_f32 v82, v82, v50
    v_add_f32 v83, v83, v51
    v_add_f32 v84, v84, v52
    v_add_f32 v85, v85, v53
    v_add_f32 v86, v86, v54
    v_add_f32 v87, v87, v55
    v_mul_f32 v80, v80, v88
    v_mul_f32 v81, v81, v88
    v_mul_f32 v82, v82, v88
    v_mul_f32 v83, v83, v88
    v_mul_f32 v84, v84, v88
    v_mul_f32 v85, v85, v88
    v_mul_f32 v86, v86, v88
    v_mul_f32 v87, v87, v88
    v_cvt_pk_bf16_f32 v60, v80, v81
    v_cvt_pk_bf16_f32 v61, v82, v83
    v_cvt_pk_bf16_f32 v62, v84, v85
    v_cvt_pk_bf16_f32 v63, v86, v87
    buffer_store_dwordx4 v[60:63], v36, s[28:31], s36 offen sc1
    s_lshl_b32 s47, s41, 2
    s_add_u32 s47, s47, s33
    s_lshl_b32 s47, s47, 5
    s_add_u32 s47, s47, s40
    s_lshl_b32 s47, s47, 1
    s_add_u32 s47, s47, s34
    s_lshl_b32 s47, s47, 3
    s_add_u32 s47, s47, 7536640
    v_mov_b32 v5, s27
    v_mov_b32 v6, 0
    s_mov_b32 s52, s20
    s_mov_b32 s53, s21
    s_mov_b32 s54, 4194304
    s_mov_b32 s55, 0x20000
    v_lshlrev_b32 v2, 4, v0
    s_and_b32 s56, s26, 1
    s_lshr_b32 s57, s26, 1
    s_lshr_b32 s58, s40, 3
    s_lshl_b32 s59, s41, 2
    s_add_u32 s59, s59, s58
    v_lshrrev_b32 v7, 5, v0
    v_bfe_u32 v8, v0, 2, 2
    v_lshl_add_u32 v9, v7, 2, v8
    v_bfe_u32 v10, v0, 4, 1
    v_lshlrev_b32 v10, 1, v10
    v_bfe_u32 v11, v0, 1, 1
    v_add_u32 v10, v10, v11
    v_and_b32 v8, 2, v8
    v_lshlrev_b32 v8, 1, v8
    v_xor_b32 v10, v10, v8
    v_lshlrev_b32 v10, 4, v10
    v_lshl_add_u32 v10, v9, 7, v10
    v_and_b32 v11, 1, v0
    v_lshl_add_u32 v10, v11, 3, v10
    s_lshl_b32 s60, s57, 14
    v_add_u32 v10, s60, v10
    v_xor_b32 v11, 64, v10
    s_lshl_b32 s61, s59, 16
    s_lshl_b32 s62, s56, 15
    s_add_u32 s61, s61, s62
    s_lshl_b32 s62, s57, 13
    s_add_u32 s61, s61, s62
    s_add_u32 s61, s61, 8388608
    s_add_u32 s62, s61, 4096
    s_barrier
    ds_read_b64_tr_b16 v[64:65], v10 offset:0
    ds_read_b64_tr_b16 v[66:67], v10 offset:1024
    ds_read_b64_tr_b16 v[68:69], v11 offset:0
    ds_read_b64_tr_b16 v[70:71], v11 offset:1024
    ds_read_b64_tr_b16 v[72:73], v10 offset:2048
    ds_read_b64_tr_b16 v[74:75], v10 offset:3072
    ds_read_b64_tr_b16 v[76:77], v11 offset:2048
    ds_read_b64_tr_b16 v[78:79], v11 offset:3072
    s_waitcnt lgkmcnt(4)
    ds_read_b64_tr_b16 v[80:81], v10 offset:4096
    ds_read_b64_tr_b16 v[82:83], v10 offset:5120
    ds_read_b64_tr_b16 v[84:85], v11 offset:4096
    ds_read_b64_tr_b16 v[86:87], v11 offset:5120
    ds_read_b64_tr_b16 v[88:89], v10 offset:6144
    ds_read_b64_tr_b16 v[90:91], v10 offset:7168
    ds_read_b64_tr_b16 v[92:93], v11 offset:6144
    ds_read_b64_tr_b16 v[94:95], v11 offset:7168
    s_waitcnt lgkmcnt(4)
    ds_read_b64_tr_b16 v[96:97], v10 offset:8192
    ds_read_b64_tr_b16 v[98:99], v10 offset:9216
    ds_read_b64_tr_b16 v[100:101], v11 offset:8192
    ds_read_b64_tr_b16 v[102:103], v11 offset:9216
    ds_read_b64_tr_b16 v[104:105], v10 offset:10240
    ds_read_b64_tr_b16 v[106:107], v10 offset:11264
    ds_read_b64_tr_b16 v[108:109], v11 offset:10240
    ds_read_b64_tr_b16 v[110:111], v11 offset:11264
    s_waitcnt lgkmcnt(4)
    ds_read_b64_tr_b16 v[112:113], v10 offset:12288
    ds_read_b64_tr_b16 v[114:115], v10 offset:13312
    ds_read_b64_tr_b16 v[116:117], v11 offset:12288
    ds_read_b64_tr_b16 v[118:119], v11 offset:13312
    ds_read_b64_tr_b16 v[120:121], v10 offset:14336
    ds_read_b64_tr_b16 v[122:123], v10 offset:15360
    ds_read_b64_tr_b16 v[124:125], v11 offset:14336
    ds_read_b64_tr_b16 v[126:127], v11 offset:15360
    buffer_load_dwordx4 v[16:19], v2, s[28:31], s61 offen offset:0 sc1
    buffer_load_dwordx4 v[20:23], v2, s[28:31], s61 offen offset:1024 sc1
    buffer_load_dwordx4 v[24:27], v2, s[28:31], s61 offen offset:2048 sc1
    buffer_load_dwordx4 v[28:31], v2, s[28:31], s61 offen offset:3072 sc1
    buffer_load_dwordx4 v[32:35], v2, s[28:31], s62 offen offset:0 sc1
    buffer_load_dwordx4 v[36:39], v2, s[28:31], s62 offen offset:1024 sc1
    buffer_load_dwordx4 v[40:43], v2, s[28:31], s62 offen offset:2048 sc1
    buffer_load_dwordx4 v[44:47], v2, s[28:31], s62 offen offset:3072 sc1
    v_mov_b64 v[128:129], 0
    v_mov_b64 v[130:131], 0
    v_mov_b64 v[132:133], 0
    v_mov_b64 v[134:135], 0
    v_mov_b64 v[136:137], 0
    v_mov_b64 v[138:139], 0
    v_mov_b64 v[140:141], 0
    v_mov_b64 v[142:143], 0
    v_mov_b64 v[144:145], 0
    v_mov_b64 v[146:147], 0
    v_mov_b64 v[148:149], 0
    v_mov_b64 v[150:151], 0
    v_mov_b64 v[152:153], 0
    v_mov_b64 v[154:155], 0
    v_mov_b64 v[156:157], 0
    v_mov_b64 v[158:159], 0
    s_mov_b32 s64, 0xff
    s_mov_b32 s65, -1
    s_mov_b32 s68, 65536
    s_lshl_b32 s63, s56, 2
    s_add_u32 s60, s63, s57
    s_mulk_i32 s60, 8704
    s_add_u32 s60, s60, 65536
    v_and_b32 v15, 31, v0
    v_mul_u32_u24 v13, 272, v15
    v_lshl_add_u32 v13, v7, 4, v13
    v_add_u32 v13, s60, v13
    s_mul_i32 s60, s63, 8704
    s_mul_i32 s63, s57, 2176
    s_add_u32 s60, s60, s63
    s_add_u32 s60, s60, 65536
    v_lshrrev_b32 v15, 3, v0
    v_mul_u32_u24 v14, 272, v15
    v_and_b32 v12, 7, v0
    v_lshl_add_u32 v14, v12, 5, v14
    v_add_u32 v14, s60, v14
    v_lshlrev_b32 v15, 11, v15
    v_lshl_add_u32 v15, v12, 4, v15
    s_lshl_b32 s60, s59, 6
    s_lshl_b32 s63, s56, 5
    s_add_u32 s60, s60, s63
    s_lshl_b32 s63, s57, 3
    s_add_u32 s60, s60, s63
    s_lshl_b32 s60, s60, 11
    s_lshl_b32 s63, s44, 7
    s_add_u32 s60, s60, s63
    s_waitcnt lgkmcnt(0)
    s_waitcnt vmcnt(7)
    v_max3_u32 v12, v16, v17, v18
    v_max_u32 v12, v12, v19
    v_cmp_eq_u32 vcc, s65, v12
    s_cbranch_vccnz K3_A0
    s_bitset0_b32 s64, 0
    v_mfma_f32_32x32x16_bf16 v[128:143], v[64:67], v[16:19], v[128:143]
    v_mfma_f32_32x32x16_bf16 v[144:159], v[68:71], v[16:19], v[144:159]
K3_A0:
    s_waitcnt vmcnt(6)
    v_max3_u32 v12, v20, v21, v22
    v_max_u32 v12, v12, v23
    v_cmp_eq_u32 vcc, s65, v12
    s_cbranch_vccnz K3_A1
    s_bitset0_b32 s64, 1
    v_mfma_f32_32x32x16_bf16 v[128:143], v[72:75], v[20:23], v[128:143]
    v_mfma_f32_32x32x16_bf16 v[144:159], v[76:79], v[20:23], v[144:159]
K3_A1:
    s_waitcnt vmcnt(5)
    v_max3_u32 v12, v24, v25, v26
    v_max_u32 v12, v12, v27
    v_cmp_eq_u32 vcc, s65, v12
    s_cbranch_vccnz K3_A2
    s_bitset0_b32 s64, 2
    v_mfma_f32_32x32x16_bf16 v[128:143], v[80:83], v[24:27], v[128:143]
    v_mfma_f32_32x32x16_bf16 v[144:159], v[84:87], v[24:27], v[144:159]
K3_A2:
    s_waitcnt vmcnt(4)
    v_max3_u32 v12, v28, v29, v30
    v_max_u32 v12, v12, v31
    v_cmp_eq_u32 vcc, s65, v12
    s_cbranch_vccnz K3_A3
    s_bitset0_b32 s64, 3
    v_mfma_f32_32x32x16_bf16 v[128:143], v[88:91], v[28:31], v[128:143]
    v_mfma_f32_32x32x16_bf16 v[144:159], v[92:95], v[28:31], v[144:159]
K3_A3:
    s_waitcnt vmcnt(3)
    v_max3_u32 v12, v32, v33, v34
    v_max_u32 v12, v12, v35
    v_cmp_eq_u32 vcc, s65, v12
    s_cbranch_vccnz K3_A4
    s_bitset0_b32 s64, 4
    v_mfma_f32_32x32x16_bf16 v[128:143], v[96:99], v[32:35], v[128:143]
    v_mfma_f32_32x32x16_bf16 v[144:159], v[100:103], v[32:35], v[144:159]
K3_A4:
    s_waitcnt vmcnt(2)
    v_max3_u32 v12, v36, v37, v38
    v_max_u32 v12, v12, v39
    v_cmp_eq_u32 vcc, s65, v12
    s_cbranch_vccnz K3_A5
    s_bitset0_b32 s64, 5
    v_mfma_f32_32x32x16_bf16 v[128:143], v[104:107], v[36:39], v[128:143]
    v_mfma_f32_32x32x16_bf16 v[144:159], v[108:111], v[36:39], v[144:159]
K3_A5:
    s_waitcnt vmcnt(1)
    v_max3_u32 v12, v40, v41, v42
    v_max_u32 v12, v12, v43
    v_cmp_eq_u32 vcc, s65, v12
    s_cbranch_vccnz K3_A6
    s_bitset0_b32 s64, 6
    v_mfma_f32_32x32x16_bf16 v[128:143], v[112:115], v[40:43], v[128:143]
    v_mfma_f32_32x32x16_bf16 v[144:159], v[116:119], v[40:43], v[144:159]
K3_A6:
    s_waitcnt vmcnt(0)
    v_max3_u32 v12, v44, v45, v46
    v_max_u32 v12, v12, v47
    v_cmp_eq_u32 vcc, s65, v12
    s_cbranch_vccnz K3_A7
    s_bitset0_b32 s64, 7
    v_mfma_f32_32x32x16_bf16 v[128:143], v[120:123], v[44:47], v[128:143]
    v_mfma_f32_32x32x16_bf16 v[144:159], v[124:127], v[44:47], v[144:159]
K3_A7:
K3_RETRY:
    s_cmp_eq_u32 s64, 0
    s_cbranch_scc1 K3_DONE
    s_sub_u32 s68, s68, 1
    s_cselect_b32 s66, 0x12345, -1
    s_bitcmp1_b32 s64, 0
    s_cbranch_scc0 K3_L0
    buffer_load_dwordx4 v[16:19], v2, s[28:31], s61 offen offset:0 sc1
K3_L0:
    s_bitcmp1_b32 s64, 1
    s_cbranch_scc0 K3_L1
    buffer_load_dwordx4 v[20:23], v2, s[28:31], s61 offen offset:1024 sc1
K3_L1:
    s_bitcmp1_b32 s64, 2
    s_cbranch_scc0 K3_L2
    buffer_load_dwordx4 v[24:27], v2, s[28:31], s61 offen offset:2048 sc1
K3_L2:
    s_bitcmp1_b32 s64, 3
    s_cbranch_scc0 K3_L3
    buffer_load_dwordx4 v[28:31], v2, s[28:31], s61 offen offset:3072 sc1
K3_L3:
    s_bitcmp1_b32 s64, 4
    s_cbranch_scc0 K3_L4
    buffer_load_dwordx4 v[32:35], v2, s[28:31], s62 offen offset:0 sc1
K3_L4:
    s_bitcmp1_b32 s64, 5
    s_cbranch_scc0 K3_L5
    buffer_load_dwordx4 v[36:39], v2, s[28:31], s62 offen offset:1024 sc1
K3_L5:
    s_bitcmp1_b32 s64, 6
    s_cbranch_scc0 K3_L6
    buffer_load_dwordx4 v[40:43], v2, s[28:31], s62 offen offset:2048 sc1
K3_L6:
    s_bitcmp1_b32 s64, 7
    s_cbranch_scc0 K3_L7
    buffer_load_dwordx4 v[44:47], v2, s[28:31], s62 offen offset:3072 sc1
K3_L7:
    s_mov_b32 s65, s66
    s_waitcnt vmcnt(0)
    s_bitcmp1_b32 s64, 0
    s_cbranch_scc0 K3_B0
    v_max3_u32 v12, v16, v17, v18
    v_max_u32 v12, v12, v19
    v_cmp_eq_u32 vcc, s65, v12
    s_cbranch_vccnz K3_B0
    s_bitset0_b32 s64, 0
    v_mfma_f32_32x32x16_bf16 v[128:143], v[64:67], v[16:19], v[128:143]
    v_mfma_f32_32x32x16_bf16 v[144:159], v[68:71], v[16:19], v[144:159]
K3_B0:
    s_bitcmp1_b32 s64, 1
    s_cbranch_scc0 K3_B1
    v_max3_u32 v12, v20, v21, v22
    v_max_u32 v12, v12, v23
    v_cmp_eq_u32 vcc, s65, v12
    s_cbranch_vccnz K3_B1
    s_bitset0_b32 s64, 1
    v_mfma_f32_32x32x16_bf16 v[128:143], v[72:75], v[20:23], v[128:143]
    v_mfma_f32_32x32x16_bf16 v[144:159], v[76:79], v[20:23], v[144:159]
K3_B1:
    s_bitcmp1_b32 s64, 2
    s_cbranch_scc0 K3_B2
    v_max3_u32 v12, v24, v25, v26
    v_max_u32 v12, v12, v27
    v_cmp_eq_u32 vcc, s65, v12
    s_cbranch_vccnz K3_B2
    s_bitset0_b32 s64, 2
    v_mfma_f32_32x32x16_bf16 v[128:143], v[80:83], v[24:27], v[128:143]
    v_mfma_f32_32x32x16_bf16 v[144:159], v[84:87], v[24:27], v[144:159]
K3_B2:
    s_bitcmp1_b32 s64, 3
    s_cbranch_scc0 K3_B3
    v_max3_u32 v12, v28, v29, v30
    v_max_u32 v12, v12, v31
    v_cmp_eq_u32 vcc, s65, v12
    s_cbranch_vccnz K3_B3
    s_bitset0_b32 s64, 3
    v_mfma_f32_32x32x16_bf16 v[128:143], v[88:91], v[28:31], v[128:143]
    v_mfma_f32_32x32x16_bf16 v[144:159], v[92:95], v[28:31], v[144:159]
K3_B3:
    s_bitcmp1_b32 s64, 4
    s_cbranch_scc0 K3_B4
    v_max3_u32 v12, v32, v33, v34
    v_max_u32 v12, v12, v35
    v_cmp_eq_u32 vcc, s65, v12
    s_cbranch_vccnz K3_B4
    s_bitset0_b32 s64, 4
    v_mfma_f32_32x32x16_bf16 v[128:143], v[96:99], v[32:35], v[128:143]
    v_mfma_f32_32x32x16_bf16 v[144:159], v[100:103], v[32:35], v[144:159]
K3_B4:
    s_bitcmp1_b32 s64, 5
    s_cbranch_scc0 K3_B5
    v_max3_u32 v12, v36, v37, v38
    v_max_u32 v12, v12, v39
    v_cmp_eq_u32 vcc, s65, v12
    s_cbranch_vccnz K3_B5
    s_bitset0_b32 s64, 5
    v_mfma_f32_32x32x16_bf16 v[128:143], v[104:107], v[36:39], v[128:143]
    v_mfma_f32_32x32x16_bf16 v[144:159], v[108:111], v[36:39], v[144:159]
K3_B5:
    s_bitcmp1_b32 s64, 6
    s_cbranch_scc0 K3_B6
    v_max3_u32 v12, v40, v41, v42
    v_max_u32 v12, v12, v43
    v_cmp_eq_u32 vcc, s65, v12
    s_cbranch_vccnz K3_B6
    s_bitset0_b32 s64, 6
    v_mfma_f32_32x32x16_bf16 v[128:143], v[112:115], v[40:43], v[128:143]
    v_mfma_f32_32x32x16_bf16 v[144:159], v[116:119], v[40:43], v[144:159]
K3_B6:
    s_bitcmp1_b32 s64, 7
    s_cbranch_scc0 K3_B7
    v_max3_u32 v12, v44, v45, v46
    v_max_u32 v12, v12, v47
    v_cmp_eq_u32 vcc, s65, v12
    s_cbranch_vccnz K3_B7
    s_bitset0_b32 s64, 7
    v_mfma_f32_32x32x16_bf16 v[128:143], v[120:123], v[44:47], v[128:143]
    v_mfma_f32_32x32x16_bf16 v[144:159], v[124:127], v[44:47], v[144:159]
K3_B7:
    s_cmp_lg_u32 s65, -1
    s_cbranch_scc0 K3_RETRY
K3_DONE:
    s_nop 11
    ds_write_b128 v13, v[128:131] offset:0
    ds_write_b128 v13, v[132:135] offset:32
    ds_write_b128 v13, v[136:139] offset:64
    ds_write_b128 v13, v[140:143] offset:96
    ds_write_b128 v13, v[144:147] offset:128
    ds_write_b128 v13, v[148:151] offset:160
    ds_write_b128 v13, v[152:155] offset:192
    ds_write_b128 v13, v[156:159] offset:224
    s_waitcnt lgkmcnt(0)
    s_barrier
    ds_read_b128 v[16:19], v14 offset:0
    ds_read_b128 v[20:23], v14 offset:16
    ds_read_b128 v[24:27], v14 offset:8704
    ds_read_b128 v[28:31], v14 offset:8720
    ds_read_b128 v[32:35], v14 offset:17408
    ds_read_b128 v[36:39], v14 offset:17424
    ds_read_b128 v[40:43], v14 offset:26112
    ds_read_b128 v[44:47], v14 offset:26128
    s_waitcnt lgkmcnt(4)
    v_add_f32 v16, v16, v24
    v_add_f32 v17, v17, v25
    v_add_f32 v18, v18, v26
    v_add_f32 v19, v19, v27
    v_add_f32 v20, v20, v28
    v_add_f32 v21, v21, v29
    v_add_f32 v22, v22, v30
    v_add_f32 v23, v23, v31
    s_waitcnt lgkmcnt(0)
    v_add_f32 v32, v32, v40
    v_add_f32 v33, v33, v41
    v_add_f32 v34, v34, v42
    v_add_f32 v35, v35, v43
    v_add_f32 v36, v36, v44
    v_add_f32 v37, v37, v45
    v_add_f32 v38, v38, v46
    v_add_f32 v39, v39, v47
    v_add_f32 v16, v16, v32
    v_add_f32 v17, v17, v33
    v_add_f32 v18, v18, v34
    v_add_f32 v19, v19, v35
    v_add_f32 v20, v20, v36
    v_add_f32 v21, v21, v37
    v_add_f32 v22, v22, v38
    v_add_f32 v23, v23, v39
    v_cvt_pk_bf16_f32 v48, v16, v17
    v_cvt_pk_bf16_f32 v49, v18, v19
    v_cvt_pk_bf16_f32 v50, v20, v21
    v_cvt_pk_bf16_f32 v51, v22, v23
    buffer_store_dwordx4 v[48:51], v15, s[52:55], s60 offen
K_END:
    s_endpgm
.section .rodata,"a"
.p2align 6
.amdhsa_kernel concat_heads__mha_block__spectral_fnet__prompt_kernel
  .amdhsa_next_free_vgpr 160
  .amdhsa_next_free_sgpr 100
  .amdhsa_accum_offset 160
  .amdhsa_group_segment_fixed_size 0
  .amdhsa_kernarg_size 88
  .amdhsa_user_sgpr_count 2
  .amdhsa_user_sgpr_kernarg_segment_ptr 1
  .amdhsa_system_sgpr_workgroup_id_x 1
.end_amdhsa_kernel
```
